```python
import torch

def _softmax(x, axis=-1):
    return torch.softmax(x, dim=axis)
def _gelu(x):
    return torch.nn.functional.gelu(x, approximate="tanh")
def _silu(x):
    return torch.nn.functional.silu(x)
def _sigmoid(x):
    return torch.sigmoid(x)
def _layernorm(x, axis=-1, eps=1e-5):
    m = x.mean(dim=axis, keepdim=True)
    v = x.var(dim=axis, keepdim=True, unbiased=False)
    return (x - m) / torch.sqrt(v + eps)
def _scatter_add(tgt, idx, src, axis=0):
    return tgt.clone().index_add_(axis, idx, src)
def _segment_sum(src, seg, n):
    out = torch.zeros((n,) + src.shape[1:], dtype=src.dtype)
    return out.index_add_(0, seg, src)
def _pad(x, pw):
    flat = tuple(v for pair in reversed(pw) for v in pair)
    return torch.nn.functional.pad(x, flat)

kernel_name = 'recurrent_scan__mha_block__dense_activation_relu__prompt'

def setup_inputs():

    _w = (lambda a: (lambda t: t.to(torch.bfloat16) if t.is_floating_point() else t)(torch.as_tensor(a)))
    def _A_setup():
        B, S, D, H = 1, 2048, 640, 32
        return {
            "x": _w((lambda *s: torch.randn(*s, dtype=torch.bfloat16) * 0.05)(B, S, D)),
            "wqkv": _w((lambda *s: torch.randn(*s, dtype=torch.bfloat16) * 0.05)(D, 3 * D)),
            "wo": _w((lambda *s: torch.randn(*s, dtype=torch.bfloat16) * 0.05)(D, D)),
        }
    _A_in = _A_setup()

    def _B_setup():
        B, S, D, Dff = 1, 2048, 640, 1536
        return {
            "x": _w((lambda *s: torch.randn(*s, dtype=torch.bfloat16) * 0.05)(B, S, D)),
            "w1": _w((lambda *s: torch.randn(*s, dtype=torch.bfloat16) * 0.05)(D, Dff)),
            "w2": _w((lambda *s: torch.randn(*s, dtype=torch.bfloat16) * 0.05)(Dff, D)),
        }
    _B_in = _B_setup()

    return {
        "A_x": _A_in["x"],
        "A_wqkv": _A_in["wqkv"],
        "A_wo": _A_in["wo"],
        "B_x": _B_in["x"],
        "B_w1": _B_in["w1"],
        "B_w2": _B_in["w2"],
    }

def reference(A_x, A_wqkv, A_wo, B_x, B_w1, B_w2):
    def _A_ref(x, wqkv, wo):
        B, S, D = x.shape
        H = 32
        Dh = D // H
        qkv = (lambda x, *d: x.permute(*d))((x @ wqkv).reshape(B, S, 3, H, Dh), 2, 0, 3, 1, 4)
        q, k, v = qkv[0], qkv[1], qkv[2]
        scores = torch.einsum("bhqd,bhkd->bhqk", q, k) * (Dh ** -0.5)
        p = _softmax(scores, axis=-1)
        o = torch.einsum("bhqk,bhkd->bhqd", p, v)
        return (lambda x, *d: x.permute(*d))(o, 0, 2, 1, 3).reshape(B, S, D) @ wo

    def _B_ref(x, w1, w2):
        h = torch.einsum("bsd,df->bsf", x, w1)
        zero = torch.zeros_like(h)
        h = torch.maximum(h, zero)
        return torch.einsum("bsf,fd->bsd", h, w2)

    x = A_x
    xn = _layernorm(x, axis=-1)
    s = _A_ref(xn, A_wqkv, A_wo)
    g = _silu(_B_ref(xn, B_w1, B_w2))
    return x + s * g
```

```asm
; @launch kernel=recurrent_scan__mha_block__dense_activation_relu__prompt_kernel grid=(256,1,1) block=(768,1,1) lds=163840
.amdgcn_target "amdgcn-amd-amdhsa--gfx950"
.text
.globl recurrent_scan__mha_block__dense_activation_relu__prompt_kernel
.p2align 8
.type recurrent_scan__mha_block__dense_activation_relu__prompt_kernel,@function
recurrent_scan__mha_block__dense_activation_relu__prompt_kernel:
    s_cmp_ge_u32 s2, 256
    s_cbranch_scc1 L_end
    s_load_dwordx2 s[4:5], s[0:1], 0
    s_load_dwordx2 s[28:29], s[0:1], 8
    s_load_dwordx2 s[32:33], s[0:1], 32
    s_load_dwordx8 s[12:19], s[0:1], 32
    s_load_dwordx2 s[20:21], s[0:1], 64
    s_load_dwordx2 s[8:9], s[0:1], 16
    s_memrealtime s[46:47]
    v_lshrrev_b32 v1, 6, v0
    v_and_b32 v0, 63, v0
    v_readfirstlane_b32 s36, v1
    s_bfe_u32 s44, s2, 0x30003
    s_and_b32 s38, s2, 1
    s_lshl_b32 s38, s38, 3
    s_add_u32 s44, s44, s38
    s_bfe_u32 s38, s2, 0x20001
    s_lshl_b32 s38, s38, 2
    s_lshr_b32 s39, s2, 6
    s_add_u32 s45, s38, s39
    s_mov_b32 s60, 0
    s_and_b32 s38, s36, 14
    s_cmp_lg_u32 s38, 4
    s_cbranch_scc1 L_noxe
    s_mov_b32 s6, 0x280000
    s_mov_b32 s7, 0x20000
    v_lshlrev_b32 v1, 4, v0
    s_waitcnt lgkmcnt(0)
    v_lshrrev_b32 v48, 8, v1
    v_and_b32 v49, 0xf0, v1
    v_mul_u32_u24 v48, 1280, v48
    v_add_u32 v48, v49, v48
    s_lshl4_add_u32 s38, s44, s45
    s_lshl1_add_u32 s38, s38, s36
    s_sub_u32 s22, s38, 4
    s_mul_i32 s38, s22, 5120
    buffer_load_dwordx4 v[8:11], v48, s[4:7], s38 offen offset:0
    buffer_load_dwordx4 v[12:15], v48, s[4:7], s38 offen offset:256
    buffer_load_dwordx4 v[16:19], v48, s[4:7], s38 offen offset:512
    buffer_load_dwordx4 v[20:23], v48, s[4:7], s38 offen offset:768
    buffer_load_dwordx4 v[24:27], v48, s[4:7], s38 offen offset:1024
    s_mov_b32 s3, s22
L_noxe:
    s_cmp_ge_u32 s36, 8
    s_cbranch_scc1 L_gemmw
    v_lshrrev_b32 v1, 4, v0
    v_bfe_u32 v2, v0, 2, 2
    v_xor_b32 v2, v2, v1
    v_mul_u32_u24 v1, 3840, v1
    v_lshl_add_u32 v1, v2, 6, v1
    v_and_b32 v2, 3, v0
    v_lshl_add_u32 v112, v2, 4, v1
    v_add_u32 v113, 14336, v112
    v_add_u32 v114, 28672, v112
    v_add_u32 v115, 43008, v112
    v_lshrrev_b32 v2, 3, v0
    v_and_b32 v3, 7, v0
    v_and_b32 v4, 3, v2
    v_and_b32 v5, 4, v2
    v_lshl_add_u32 v4, v5, 1, v4
    v_mul_u32_u24 v4, 1280, v4
    v_lshrrev_b32 v5, 1, v2
    v_xor_b32 v3, v3, v5
    v_lshl_add_u32 v119, v3, 4, v4
    v_xor_b32 v3, 4, v3
    v_lshl_add_u32 v4, v3, 4, v4
    v_add_u32 v120, 4096, v4
    v_add_u32 v121, 18432, v119
    v_add_u32 v122, 22528, v4
    s_min_u32 s61, s45, 14
    s_lshl_b32 s61, s61, 8
    s_lshl2_add_u32 s22, s44, s36
    s_mul_i32 s22, s22, 40960
    s_lshl_b32 s23, s36, 12
    s_mov_b32 s62, 49152
    s_mov_b32 s63, s60
    s_mov_b32 s30, 0x258000
    s_mov_b32 s31, 0x20000
    s_mov_b32 s34, 0x1e0000
    s_mov_b32 s35, 0x20000
    s_mov_b32 s6, 0x280000
    s_mov_b32 s7, 0x20000
    s_cmp_ge_u32 s36, 4
    s_waitcnt lgkmcnt(0)
    s_cbranch_scc1 L_fl_skip
    s_mov_b32 m0, s23
    s_lshl_b32 s38, s63, 7
    s_add_u32 s38, s38, s22
    buffer_load_dwordx4 v119, s[4:7], s38 offen offset:0 lds
    buffer_load_dwordx4 v120, s[4:7], s38 offen offset:1024 lds
    buffer_load_dwordx4 v121, s[4:7], s38 offen offset:2048 lds
    buffer_load_dwordx4 v122, s[4:7], s38 offen offset:3072 lds
    s_lshl_b32 s38, s36, 12
    s_add_u32 m0, s62, s38
    s_lshl2_add_u32 s39, s63, s36
    s_mul_i32 s38, s39, 61440
    s_add_u32 s38, s38, s61
    buffer_load_dwordx4 v112, s[28:31], s38 offen offset:0 lds
    buffer_load_dwordx4 v113, s[28:31], s38 offen offset:1024 lds
    buffer_load_dwordx4 v114, s[28:31], s38 offen offset:2048 lds
    buffer_load_dwordx4 v115, s[28:31], s38 offen offset:3072 lds
    s_movk_i32 s38, 5462
    v_add_u32 v1, 0, v0
    v_mul_u32_u24 v2, s38, v1
    v_lshrrev_b32 v2, 16, v2
    v_mul_u32_u24 v3, 12, v2
    v_sub_u32 v1, v1, v3
    v_mul_u32_u24 v2, 3072, v2
    v_lshl_add_u32 v116, v1, 4, v2
    v_add_u32 v1, 64, v0
    v_mul_u32_u24 v2, s38, v1
    v_lshrrev_b32 v2, 16, v2
    v_mul_u32_u24 v3, 12, v2
    v_sub_u32 v1, v1, v3
    v_mul_u32_u24 v2, 3072, v2
    v_lshl_add_u32 v117, v1, 4, v2
    v_subrev_u32 v117, 1024, v117
    v_add_u32 v1, 128, v0
    v_mul_u32_u24 v2, s38, v1
    v_lshrrev_b32 v2, 16, v2
    v_mul_u32_u24 v3, 12, v2
    v_sub_u32 v1, v1, v3
    v_mul_u32_u24 v2, 3072, v2
    v_lshl_add_u32 v118, v1, 4, v2
    v_subrev_u32 v118, 2048, v118
    s_mul_i32 s38, s36, 3072
    s_add_u32 s38, s38, 16384
    s_add_u32 m0, s62, s38
    s_lshl_b32 s38, s39, 8
    s_add_u32 s38, s38, s45
    s_mul_i32 s38, s38, 192
    buffer_load_dwordx4 v116, s[32:35], s38 offen offset:0 lds
    buffer_load_dwordx4 v117, s[32:35], s38 offen offset:1024 lds
    buffer_load_dwordx4 v118, s[32:35], s38 offen offset:2048 lds
    s_add_u32 s62, s62, 28672
    s_cmp_eq_u32 s62, 163840
    s_cselect_b32 s62, 49152, s62
    s_add_u32 s23, s23, 16384
    s_sub_u32 s38, s23, 49152
    s_cselect_b32 s23, s23, s38
    s_add_u32 s63, s63, 1
    s_cmp_eq_u32 s63, 10
    s_cselect_b32 s63, 0, s63
L_fl_done:
    s_mov_b32 s24, s20
    s_mov_b32 s25, s21
    s_mov_b32 s26, 0x16f0000
    s_mov_b32 s27, 0x20000
    v_lshlrev_b32 v1, 4, v0
    s_mov_b32 s54, 0
    s_and_b32 s38, s2, 7
    s_lshl_b32 s38, s38, 2
    s_bfe_u32 s39, s2, 0x20003
    s_add_u32 s46, s38, s39
    s_lshr_b32 s47, s2, 5
    s_and_b32 s38, s46, 1
    s_lshr_b32 s39, s46, 1
    s_mul_i32 s39, s39, 2560
    s_mul_i32 s40, s38, 1536
    s_add_u32 s48, s39, s40
    s_lshl_b32 s40, s38, 3
    s_add_u32 s49, s39, s40
    s_add_u32 s49, s49, 1024
    v_and_b32 v128, 31, v0
    v_lshrrev_b32 v129, 5, v0
    v_lshlrev_b32 v138, 4, v128
    s_and_b32 s40, s47, 1
    v_xor_b32 v136, s40, v129
    v_mul_u32_u24 v136, 40960, v136
    v_add_u32 v136, v136, v138
    v_and_b32 v131, 0x13, v128
    v_and_b32 v132, 4, v128
    v_lshl_or_b32 v131, v132, 1, v131
    v_and_b32 v132, 8, v128
    v_lshrrev_b32 v132, 1, v132
    v_or_b32 v130, v131, v132
    s_lshl_b32 s40, s38, 2
    v_add_u32 v130, s40, v130
    s_lshl_b32 s40, s38, 4
    v_subrev_u32 v131, s40, v128
    v_cmp_gt_u32 vcc, 16, v128
    s_mul_i32 s39, s46, 320
    v_mul_u32_u24 v132, 10240, v129
    v_cndmask_b32 v130, v131, v130, vcc
    v_lshl_add_u32 v137, v130, 4, v132
    s_and_b32 s9, s36, 3
    s_lshl_b32 s9, s9, 1
    s_lshr_b32 s40, s36, 2
    s_add_u32 s9, s9, s40
    s_lshl_b32 s50, s47, 3
    s_add_u32 s50, s50, s9
    s_mul_i32 s40, s36, 327680
    s_add_u32 s51, s40, 0x280000
    s_add_u32 s52, s40, s39
    s_add_u32 s52, s52, 0x500000
    v_cmp_gt_u32 s[56:57], 32, v0
    v_and_b32 v131, 1, v0
    v_mul_u32_u24 v131, 19, v131
    s_mul_i32 s38, s46, 20
    v_add_u32 v131, s38, v131
    v_lshrrev_b32 v131, 7, v131
    v_bfe_u32 v132, v0, 1, 1
    v_mul_u32_u24 v132, 5, v132
    v_lshrrev_b32 v130, 2, v0
    v_lshl_add_u32 v132, v130, 4, v132
    s_lshl_b32 s38, s36, 7
    s_add_u32 s38, s38, 5
    v_add_u32 v132, s38, v132
    s_and_b32 s38, s50, -2
    v_bfe_u32 v130, v0, 1, 1
    v_add_lshl_u32 v130, v130, s38, 4
    v_cndmask_b32 v132, v130, v132, s[56:57]
    v_add_lshl_u32 v131, v131, v132, 7
    v_add_u32 v4, 158720, v1
    s_mul_i32 s50, s50, 40960
    s_and_b32 s40, s47, 1
    s_mul_i32 s40, s40, 40960
    s_add_u32 s17, s51, s49
    s_sub_u32 s17, s17, s40
    s_add_u32 s51, s51, s48
    v_mov_b32 v7, v136
    v_mov_b32 v5, v137
    s_lshl_b32 s53, s9, 13
    v_add_u32 v2, s53, v1
    v_bfe_u32 v142, v1, 4, 2
    v_lshlrev_b32 v142, 2, v142
    v_add_u32 v142, 161936, v142
    s_lshr_b32 s38, s36, 2
    s_mul_i32 s38, s38, 3072
    s_add_u32 s53, s53, s38
    v_add_u32 v3, s53, v1
    s_mov_b32 s42, 0
    v_mov_b32 v0, 0xdddddddd
    s_mov_b32 s12, 0xfffff
    s_mov_b32 s13, 0xfffff
    s_mov_b32 s14, -1
    s_mov_b32 s15, 0
    s_cmp_ge_u32 s36, 4
    s_cbranch_scc1 L_fr_other
    s_mov_b32 s43, 9
L_fr_ring:
    s_mov_b32 m0, s23
    s_lshl_b32 s38, s63, 7
    s_add_u32 s38, s38, s22
    buffer_load_dwordx4 v119, s[4:7], s38 offen offset:0 lds
    buffer_load_dwordx4 v120, s[4:7], s38 offen offset:1024 lds
    buffer_load_dwordx4 v121, s[4:7], s38 offen offset:2048 lds
    buffer_load_dwordx4 v122, s[4:7], s38 offen offset:3072 lds
    s_lshl_b32 s38, s36, 12
    s_add_u32 m0, s62, s38
    s_lshl2_add_u32 s39, s63, s36
    s_mul_i32 s38, s39, 61440
    s_add_u32 s38, s38, s61
    buffer_load_dwordx4 v112, s[28:31], s38 offen offset:0 lds
    buffer_load_dwordx4 v113, s[28:31], s38 offen offset:1024 lds
    buffer_load_dwordx4 v114, s[28:31], s38 offen offset:2048 lds
    buffer_load_dwordx4 v115, s[28:31], s38 offen offset:3072 lds
    s_mul_i32 s38, s36, 3072
    s_add_u32 s38, s38, 16384
    s_add_u32 m0, s62, s38
    s_lshl_b32 s38, s39, 8
    s_add_u32 s38, s38, s45
    s_mul_i32 s38, s38, 192
    buffer_load_dwordx4 v116, s[32:35], s38 offen offset:0 lds
    buffer_load_dwordx4 v117, s[32:35], s38 offen offset:1024 lds
    buffer_load_dwordx4 v118, s[32:35], s38 offen offset:2048 lds
    s_add_u32 s62, s62, 28672
    s_cmp_eq_u32 s62, 163840
    s_cselect_b32 s62, 49152, s62
    s_add_u32 s23, s23, 16384
    s_sub_u32 s38, s23, 49152
    s_cselect_b32 s23, s23, s38
    s_add_u32 s63, s63, 1
    s_cmp_eq_u32 s63, 10
    s_cselect_b32 s63, 0, s63
    s_sub_u32 s43, s43, 1
    s_cmp_lg_u32 s43, 0
    s_waitcnt vmcnt(11)
    s_barrier
    s_cbranch_scc1 L_fr_ring
    s_waitcnt vmcnt(0)
    s_barrier
    s_branch L_fr_done
L_fr_other:
    s_barrier
    s_barrier
    s_cmp_ge_u32 s36, 6
    s_cbranch_scc1 L_fr_cs
    s_mov_b32 s22, s3
    v_mov_b32 v116, 0x3f803f80
    v_mov_b32 v112, 0
    v_mov_b32 v113, 0
    v_mov_b32 v114, 0
    v_mov_b32 v115, 0
    s_barrier
    s_waitcnt vmcnt(4)
    v_dot2c_f32_bf16 v112, v8, v116
    v_dot2c_f32_bf16 v114, v8, v8
    v_dot2c_f32_bf16 v113, v9, v116
    v_dot2c_f32_bf16 v115, v9, v9
    v_dot2c_f32_bf16 v112, v10, v116
    v_dot2c_f32_bf16 v114, v10, v10
    v_dot2c_f32_bf16 v113, v11, v116
    v_dot2c_f32_bf16 v115, v11, v11
    s_waitcnt vmcnt(3)
    v_dot2c_f32_bf16 v112, v12, v116
    v_dot2c_f32_bf16 v114, v12, v12
    v_dot2c_f32_bf16 v113, v13, v116
    v_dot2c_f32_bf16 v115, v13, v13
    v_dot2c_f32_bf16 v112, v14, v116
    v_dot2c_f32_bf16 v114, v14, v14
    v_dot2c_f32_bf16 v113, v15, v116
    v_dot2c_f32_bf16 v115, v15, v15
    s_waitcnt vmcnt(2)
    v_dot2c_f32_bf16 v112, v16, v116
    v_dot2c_f32_bf16 v114, v16, v16
    v_dot2c_f32_bf16 v113, v17, v116
    v_dot2c_f32_bf16 v115, v17, v17
    v_dot2c_f32_bf16 v112, v18, v116
    v_dot2c_f32_bf16 v114, v18, v18
    v_dot2c_f32_bf16 v113, v19, v116
    v_dot2c_f32_bf16 v115, v19, v19
    s_waitcnt vmcnt(1)
    v_dot2c_f32_bf16 v112, v20, v116
    v_dot2c_f32_bf16 v114, v20, v20
    v_dot2c_f32_bf16 v113, v21, v116
    v_dot2c_f32_bf16 v115, v21, v21
    v_dot2c_f32_bf16 v112, v22, v116
    v_dot2c_f32_bf16 v114, v22, v22
    v_dot2c_f32_bf16 v113, v23, v116
    v_dot2c_f32_bf16 v115, v23, v23
    s_waitcnt vmcnt(0)
    v_dot2c_f32_bf16 v112, v24, v116
    v_dot2c_f32_bf16 v114, v24, v24
    v_dot2c_f32_bf16 v113, v25, v116
    v_dot2c_f32_bf16 v115, v25, v25
    v_dot2c_f32_bf16 v112, v26, v116
    v_dot2c_f32_bf16 v114, v26, v26
    v_dot2c_f32_bf16 v113, v27, v116
    v_dot2c_f32_bf16 v115, v27, v27
    s_nop 2
    v_add_f32 v112, v112, v113
    v_add_f32 v114, v114, v115
    s_nop 0
    v_add_f32_dpp v112, v112, v112 row_ror:1 row_mask:0xf bank_mask:0xf
    v_add_f32_dpp v114, v114, v114 row_ror:1 row_mask:0xf bank_mask:0xf
    s_nop 0
    v_add_f32_dpp v112, v112, v112 row_ror:2 row_mask:0xf bank_mask:0xf
    v_add_f32_dpp v114, v114, v114 row_ror:2 row_mask:0xf bank_mask:0xf
    s_nop 0
    v_add_f32_dpp v112, v112, v112 row_ror:4 row_mask:0xf bank_mask:0xf
    v_add_f32_dpp v114, v114, v114 row_ror:4 row_mask:0xf bank_mask:0xf
    s_nop 0
    v_add_f32_dpp v112, v112, v112 row_ror:8 row_mask:0xf bank_mask:0xf
    v_add_f32_dpp v114, v114, v114 row_ror:8 row_mask:0xf bank_mask:0xf
    v_mul_f32 v112, 0x3acccccd, v112
    v_mul_f32 v114, 0x3acccccd, v114
    v_fma_f32 v114, -v112, v112, v114
    v_max_f32 v114, 0, v114
    v_cvt_pk_bf16_f32 v114, v114, v114
    v_and_b32 v114, 0xffff0000, v114
    v_add_f32 v114, 0x3727c5ac, v114
    v_cvt_pk_bf16_f32 v114, v114, v114
    v_and_b32 v114, 0xffff0000, v114
    v_sqrt_f32 v114, v114
    v_cvt_pk_bf16_f32 v112, -v112, -v112
    v_cvt_pk_bf16_f32 v114, v114, v114
    v_and_b32 v114, 0xffff0000, v114
    v_rcp_f32 v114, v114
    v_lshrrev_b32 v113, 6, v1
    s_lshl_b32 s38, s22, 4
    s_add_u32 s38, s38, 0x1380000
    s_add_u32 s39, s38, 8192
    s_mov_b32 exec_lo, 0x10001
    s_mov_b32 exec_hi, 0x10001
    buffer_store_dword v112, v113, s[24:27], s38 offen sc1
    buffer_store_dword v114, v113, s[24:27], s39 offen sc1
    s_mov_b64 exec, -1
    s_barrier
    s_load_dword s37, s[18:19], 0
    s_waitcnt vmcnt(0) lgkmcnt(0)
    s_cmp_lg_u32 s37, 0
    s_cbranch_scc1 L_tn_1
    v_mov_b32 v113, 0
    s_mov_b32 s43, 0
L_tag_2:
    global_load_dword v112, v113, s[18:19] sc1
    s_add_u32 s43, s43, 1
    s_waitcnt vmcnt(0)
    v_readfirstlane_b32 s37, v112
    s_cmp_lg_u32 s37, 0
    s_cbranch_scc1 L_tagd_3
    s_cmp_lt_u32 s43, 65536
    s_cbranch_scc1 L_tag_2
L_tagd_3:
L_tn_1:
    s_lshl_b32 s38, s22, 7
    s_add_u32 s38, s38, 0x16b0000
    v_mov_b32 v112, s37
    s_mov_b64 exec, 0x1
    buffer_store_dword v112, off, s[24:27], s38 sc1
    s_mov_b64 exec, -1
    s_barrier
    s_barrier
    v_lshlrev_b32 v113, 3, v1
    v_and_b32 v113, 0xf80, v113
    s_cmp_eq_u32 s36, 4
    s_cselect_b32 s38, s45, s44
    s_cselect_b32 s39, 0, 0x60000
    s_lshl_b32 s38, s38, 12
    s_add_u32 s38, s38, s39
    s_add_u32 s38, s38, 0x1650000
    buffer_load_dword v112, v113, s[24:27], s38 offen sc1
    s_barrier
    s_mov_b32 s43, 0
L_poll_4:
    buffer_load_dword v112, v113, s[24:27], s38 offen sc1
    s_add_u32 s43, s43, 1
    s_waitcnt vmcnt(0)
    v_xor_b32 v112, s37, v112
    v_cmp_ne_u32 vcc, 0, v112
    s_cmp_eq_u64 vcc, 0
    s_cbranch_scc1 L_polld_5
    s_sleep 1
    s_cmp_lt_u32 s43, 65536
    s_cbranch_scc1 L_poll_4
L_polld_5:
    s_cmp_eq_u32 s36, 4
    s_cbranch_scc1 L_fr_sum
    v_lshrrev_b32 v113, 1, v1
    s_lshl_b32 s38, s44, 9
    s_add_u32 s38, s38, 0x1380000
    s_add_u32 s39, s38, 8192
    buffer_load_dwordx2 v[8:9], v113, s[24:27], s38 offen sc1
    buffer_load_dwordx2 v[10:11], v113, s[24:27], s39 offen sc1
    v_add_u32 v113, 107520, v113
    s_barrier
    s_barrier
    s_waitcnt vmcnt(0)
    ds_write_b64 v113, v[8:9]
    ds_write_b64 v113, v[10:11] offset:512
    v_mov_b32 v8, s37
    ds_write_b32 v113, v8 offset:1024
    s_waitcnt lgkmcnt(0)
    s_barrier
    s_branch L_fr_done
L_fr_sum:
    s_lshl_b32 s38, s45, 14
    s_add_u32 s38, s38, 0x1384000
    buffer_load_dwordx4 v[8:11], v1, s[24:27], s38 offen offset:0 sc1
    buffer_load_dwordx4 v[12:15], v1, s[24:27], s38 offen offset:1024 sc1
    buffer_load_dwordx4 v[16:19], v1, s[24:27], s38 offen offset:2048 sc1
    buffer_load_dwordx4 v[20:23], v1, s[24:27], s38 offen offset:3072 sc1
    s_add_u32 s38, s38, 4096
    buffer_load_dwordx4 v[24:27], v1, s[24:27], s38 offen offset:0 sc1
    buffer_load_dwordx4 v[28:31], v1, s[24:27], s38 offen offset:1024 sc1
    buffer_load_dwordx4 v[32:35], v1, s[24:27], s38 offen offset:2048 sc1
    buffer_load_dwordx4 v[36:39], v1, s[24:27], s38 offen offset:3072 sc1
    s_add_u32 s38, s38, 4096
    buffer_load_dwordx4 v[40:43], v1, s[24:27], s38 offen offset:0 sc1
    buffer_load_dwordx4 v[44:47], v1, s[24:27], s38 offen offset:1024 sc1
    buffer_load_dwordx4 v[48:51], v1, s[24:27], s38 offen offset:2048 sc1
    buffer_load_dwordx4 v[52:55], v1, s[24:27], s38 offen offset:3072 sc1
    s_add_u32 s38, s38, 4096
    buffer_load_dwordx4 v[56:59], v1, s[24:27], s38 offen offset:0 sc1
    buffer_load_dwordx4 v[60:63], v1, s[24:27], s38 offen offset:1024 sc1
    buffer_load_dwordx4 v[64:67], v1, s[24:27], s38 offen offset:2048 sc1
    buffer_load_dwordx4 v[68:71], v1, s[24:27], s38 offen offset:3072 sc1
    s_add_u32 s38, s38, 4096
    s_barrier
    s_waitcnt vmcnt(0)
    v_add_f32 v112, v8, v12
    v_add_f32 v113, v9, v13
    v_add_f32 v114, v10, v14
    v_add_f32 v115, v11, v15
    v_add_f32 v112, v112, v16
    v_add_f32 v113, v113, v17
    v_add_f32 v114, v114, v18
    v_add_f32 v115, v115, v19
    v_add_f32 v112, v112, v20
    v_add_f32 v113, v113, v21
    v_add_f32 v114, v114, v22
    v_add_f32 v115, v115, v23
    v_add_f32 v112, v112, v24
    v_add_f32 v113, v113, v25
    v_add_f32 v114, v114, v26
    v_add_f32 v115, v115, v27
    v_add_f32 v112, v112, v28
    v_add_f32 v113, v113, v29
    v_add_f32 v114, v114, v30
    v_add_f32 v115, v115, v31
    v_add_f32 v112, v112, v32
    v_add_f32 v113, v113, v33
    v_add_f32 v114, v114, v34
    v_add_f32 v115, v115, v35
    v_add_f32 v112, v112, v36
    v_add_f32 v113, v113, v37
    v_add_f32 v114, v114, v38
    v_add_f32 v115, v115, v39
    v_add_f32 v112, v112, v40
    v_add_f32 v113, v113, v41
    v_add_f32 v114, v114, v42
    v_add_f32 v115, v115, v43
    v_add_f32 v112, v112, v44
    v_add_f32 v113, v113, v45
    v_add_f32 v114, v114, v46
    v_add_f32 v115, v115, v47
    v_add_f32 v112, v112, v48
    v_add_f32 v113, v113, v49
    v_add_f32 v114, v114, v50
    v_add_f32 v115, v115, v51
    v_add_f32 v112, v112, v52
    v_add_f32 v113, v113, v53
    v_add_f32 v114, v114, v54
    v_add_f32 v115, v115, v55
    v_add_f32 v112, v112, v56
    v_add_f32 v113, v113, v57
    v_add_f32 v114, v114, v58
    v_add_f32 v115, v115, v59
    v_add_f32 v112, v112, v60
    v_add_f32 v113, v113, v61
    v_add_f32 v114, v114, v62
    v_add_f32 v115, v115, v63
    v_add_f32 v112, v112, v64
    v_add_f32 v113, v113, v65
    v_add_f32 v114, v114, v66
    v_add_f32 v115, v115, v67
    v_add_f32 v112, v112, v68
    v_add_f32 v113, v113, v69
    v_add_f32 v114, v114, v70
    v_add_f32 v115, v115, v71
    v_and_b32 v116, 0xffff0000, v112
    v_sub_f32 v117, v112, v116
    v_cvt_pk_bf16_f32 v120, v117, v116
    v_and_b32 v116, 0xffff0000, v113
    v_sub_f32 v117, v113, v116
    v_cvt_pk_bf16_f32 v121, v117, v116
    v_and_b32 v116, 0xffff0000, v114
    v_sub_f32 v117, v114, v116
    v_cvt_pk_bf16_f32 v122, v117, v116
    v_and_b32 v116, 0xffff0000, v115
    v_sub_f32 v117, v115, v116
    v_cvt_pk_bf16_f32 v123, v117, v116
    v_add_u32 v116, 106496, v1
    s_barrier
    s_mov_b32 exec_hi, 0xffffff
    ds_write_b128 v116, v[120:123]
    s_mov_b64 exec, -1
    s_waitcnt lgkmcnt(0)
    s_barrier
    s_branch L_fr_done
L_fr_cs:
    s_cmp_eq_u32 s36, 7
    s_cselect_b64 s[28:29], s[32:33], s[28:29]
    s_cselect_b32 s30, s34, s30
    s_cselect_b32 s39, 12, 15
    s_mul_i32 s38, s45, 192
    s_cselect_b32 s38, s38, s61
    s_lshl_b32 s39, s39, 8
    v_lshrrev_b32 v48, 8, v1
    v_and_b32 v49, 0xf0, v1
    v_mul_u32_u24 v48, s39, v48
    v_add_u32 v48, v49, v48
    s_mul_i32 s40, s44, 40
    s_mul_i32 s40, s40, s39
    s_add_u32 s38, s38, s40
    s_lshl_b32 s39, s39, 2
    buffer_load_dwordx4 v[8:11], v48, s[28:31], s38 offen
    s_add_u32 s38, s38, s39
    buffer_load_dwordx4 v[12:15], v48, s[28:31], s38 offen
    s_add_u32 s38, s38, s39
    buffer_load_dwordx4 v[16:19], v48, s[28:31], s38 offen
    s_add_u32 s38, s38, s39
    buffer_load_dwordx4 v[20:23], v48, s[28:31], s38 offen
    s_add_u32 s38, s38, s39
    buffer_load_dwordx4 v[24:27], v48, s[28:31], s38 offen
    s_add_u32 s38, s38, s39
    buffer_load_dwordx4 v[28:31], v48, s[28:31], s38 offen
    s_add_u32 s38, s38, s39
    buffer_load_dwordx4 v[32:35], v48, s[28:31], s38 offen
    s_add_u32 s38, s38, s39
    buffer_load_dwordx4 v[36:39], v48, s[28:31], s38 offen
    s_add_u32 s38, s38, s39
    buffer_load_dwordx4 v[40:43], v48, s[28:31], s38 offen
    s_add_u32 s38, s38, s39
    buffer_load_dwordx4 v[44:47], v48, s[28:31], s38 offen
    s_add_u32 s38, s38, s39
    s_barrier
    s_waitcnt vmcnt(9)
    v_lshlrev_b32 v112, 16, v8
    v_and_b32 v113, 0xffff0000, v8
    v_lshlrev_b32 v114, 16, v9
    v_and_b32 v115, 0xffff0000, v9
    v_lshlrev_b32 v116, 16, v10
    v_and_b32 v117, 0xffff0000, v10
    v_lshlrev_b32 v118, 16, v11
    v_and_b32 v119, 0xffff0000, v11
    s_waitcnt vmcnt(8)
    v_lshlrev_b32 v120, 16, v12
    v_and_b32 v12, 0xffff0000, v12
    v_add_f32 v112, v112, v120
    v_add_f32 v113, v113, v12
    v_lshlrev_b32 v120, 16, v13
    v_and_b32 v13, 0xffff0000, v13
    v_add_f32 v114, v114, v120
    v_add_f32 v115, v115, v13
    v_lshlrev_b32 v120, 16, v14
    v_and_b32 v14, 0xffff0000, v14
    v_add_f32 v116, v116, v120
    v_add_f32 v117, v117, v14
    v_lshlrev_b32 v120, 16, v15
    v_and_b32 v15, 0xffff0000, v15
    v_add_f32 v118, v118, v120
    v_add_f32 v119, v119, v15
    s_waitcnt vmcnt(7)
    v_lshlrev_b32 v120, 16, v16
    v_and_b32 v16, 0xffff0000, v16
    v_add_f32 v112, v112, v120
    v_add_f32 v113, v113, v16
    v_lshlrev_b32 v120, 16, v17
    v_and_b32 v17, 0xffff0000, v17
    v_add_f32 v114, v114, v120
    v_add_f32 v115, v115, v17
    v_lshlrev_b32 v120, 16, v18
    v_and_b32 v18, 0xffff0000, v18
    v_add_f32 v116, v116, v120
    v_add_f32 v117, v117, v18
    v_lshlrev_b32 v120, 16, v19
    v_and_b32 v19, 0xffff0000, v19
    v_add_f32 v118, v118, v120
    v_add_f32 v119, v119, v19
    s_waitcnt vmcnt(6)
    v_lshlrev_b32 v120, 16, v20
    v_and_b32 v20, 0xffff0000, v20
    v_add_f32 v112, v112, v120
    v_add_f32 v113, v113, v20
    v_lshlrev_b32 v120, 16, v21
    v_and_b32 v21, 0xffff0000, v21
    v_add_f32 v114, v114, v120
    v_add_f32 v115, v115, v21
    v_lshlrev_b32 v120, 16, v22
    v_and_b32 v22, 0xffff0000, v22
    v_add_f32 v116, v116, v120
    v_add_f32 v117, v117, v22
    v_lshlrev_b32 v120, 16, v23
    v_and_b32 v23, 0xffff0000, v23
    v_add_f32 v118, v118, v120
    v_add_f32 v119, v119, v23
    s_waitcnt vmcnt(5)
    v_lshlrev_b32 v120, 16, v24
    v_and_b32 v24, 0xffff0000, v24
    v_add_f32 v112, v112, v120
    v_add_f32 v113, v113, v24
    v_lshlrev_b32 v120, 16, v25
    v_and_b32 v25, 0xffff0000, v25
    v_add_f32 v114, v114, v120
    v_add_f32 v115, v115, v25
    v_lshlrev_b32 v120, 16, v26
    v_and_b32 v26, 0xffff0000, v26
    v_add_f32 v116, v116, v120
    v_add_f32 v117, v117, v26
    v_lshlrev_b32 v120, 16, v27
    v_and_b32 v27, 0xffff0000, v27
    v_add_f32 v118, v118, v120
    v_add_f32 v119, v119, v27
    s_waitcnt vmcnt(4)
    v_lshlrev_b32 v120, 16, v28
    v_and_b32 v28, 0xffff0000, v28
    v_add_f32 v112, v112, v120
    v_add_f32 v113, v113, v28
    v_lshlrev_b32 v120, 16, v29
    v_and_b32 v29, 0xffff0000, v29
    v_add_f32 v114, v114, v120
    v_add_f32 v115, v115, v29
    v_lshlrev_b32 v120, 16, v30
    v_and_b32 v30, 0xffff0000, v30
    v_add_f32 v116, v116, v120
    v_add_f32 v117, v117, v30
    v_lshlrev_b32 v120, 16, v31
    v_and_b32 v31, 0xffff0000, v31
    v_add_f32 v118, v118, v120
    v_add_f32 v119, v119, v31
    s_barrier
    s_waitcnt vmcnt(3)
    v_lshlrev_b32 v120, 16, v32
    v_and_b32 v32, 0xffff0000, v32
    v_add_f32 v112, v112, v120
    v_add_f32 v113, v113, v32
    v_lshlrev_b32 v120, 16, v33
    v_and_b32 v33, 0xffff0000, v33
    v_add_f32 v114, v114, v120
    v_add_f32 v115, v115, v33
    v_lshlrev_b32 v120, 16, v34
    v_and_b32 v34, 0xffff0000, v34
    v_add_f32 v116, v116, v120
    v_add_f32 v117, v117, v34
    v_lshlrev_b32 v120, 16, v35
    v_and_b32 v35, 0xffff0000, v35
    v_add_f32 v118, v118, v120
    v_add_f32 v119, v119, v35
    s_waitcnt vmcnt(2)
    v_lshlrev_b32 v120, 16, v36
    v_and_b32 v36, 0xffff0000, v36
    v_add_f32 v112, v112, v120
    v_add_f32 v113, v113, v36
    v_lshlrev_b32 v120, 16, v37
    v_and_b32 v37, 0xffff0000, v37
    v_add_f32 v114, v114, v120
    v_add_f32 v115, v115, v37
    v_lshlrev_b32 v120, 16, v38
    v_and_b32 v38, 0xffff0000, v38
    v_add_f32 v116, v116, v120
    v_add_f32 v117, v117, v38
    v_lshlrev_b32 v120, 16, v39
    v_and_b32 v39, 0xffff0000, v39
    v_add_f32 v118, v118, v120
    v_add_f32 v119, v119, v39
    s_waitcnt vmcnt(1)
    v_lshlrev_b32 v120, 16, v40
    v_and_b32 v40, 0xffff0000, v40
    v_add_f32 v112, v112, v120
    v_add_f32 v113, v113, v40
    v_lshlrev_b32 v120, 16, v41
    v_and_b32 v41, 0xffff0000, v41
    v_add_f32 v114, v114, v120
    v_add_f32 v115, v115, v41
    v_lshlrev_b32 v120, 16, v42
    v_and_b32 v42, 0xffff0000, v42
    v_add_f32 v116, v116, v120
    v_add_f32 v117, v117, v42
    v_lshlrev_b32 v120, 16, v43
    v_and_b32 v43, 0xffff0000, v43
    v_add_f32 v118, v118, v120
    v_add_f32 v119, v119, v43
    s_waitcnt vmcnt(0)
    v_lshlrev_b32 v120, 16, v44
    v_and_b32 v44, 0xffff0000, v44
    v_add_f32 v112, v112, v120
    v_add_f32 v113, v113, v44
    v_lshlrev_b32 v120, 16, v45
    v_and_b32 v45, 0xffff0000, v45
    v_add_f32 v114, v114, v120
    v_add_f32 v115, v115, v45
    v_lshlrev_b32 v120, 16, v46
    v_and_b32 v46, 0xffff0000, v46
    v_add_f32 v116, v116, v120
    v_add_f32 v117, v117, v46
    v_lshlrev_b32 v120, 16, v47
    v_and_b32 v47, 0xffff0000, v47
    v_add_f32 v118, v118, v120
    v_add_f32 v119, v119, v47
    v_mov_b32 v8, v112
    v_mov_b32 v9, v113
    v_mov_b32 v10, v114
    v_mov_b32 v11, v115
    v_mov_b32 v12, v116
    v_mov_b32 v13, v117
    v_mov_b32 v14, v118
    v_mov_b32 v15, v119
    v_permlane16_swap_b32 v112, v8
    v_permlane16_swap_b32 v113, v9
    v_permlane16_swap_b32 v114, v10
    v_permlane16_swap_b32 v115, v11
    v_permlane16_swap_b32 v116, v12
    v_permlane16_swap_b32 v117, v13
    v_permlane16_swap_b32 v118, v14
    v_permlane16_swap_b32 v119, v15
    v_add_f32 v112, v112, v8
    v_add_f32 v113, v113, v9
    v_add_f32 v114, v114, v10
    v_add_f32 v115, v115, v11
    v_add_f32 v116, v116, v12
    v_add_f32 v117, v117, v13
    v_add_f32 v118, v118, v14
    v_add_f32 v119, v119, v15
    v_mov_b32 v8, v112
    v_mov_b32 v9, v113
    v_mov_b32 v10, v114
    v_mov_b32 v11, v115
    v_mov_b32 v12, v116
    v_mov_b32 v13, v117
    v_mov_b32 v14, v118
    v_mov_b32 v15, v119
    v_permlane32_swap_b32 v112, v8
    v_permlane32_swap_b32 v113, v9
    v_permlane32_swap_b32 v114, v10
    v_permlane32_swap_b32 v115, v11
    v_permlane32_swap_b32 v116, v12
    v_permlane32_swap_b32 v117, v13
    v_permlane32_swap_b32 v118, v14
    v_permlane32_swap_b32 v119, v15
    v_add_f32 v112, v112, v8
    v_add_f32 v113, v113, v9
    v_add_f32 v114, v114, v10
    v_add_f32 v115, v115, v11
    v_add_f32 v116, v116, v12
    v_add_f32 v117, v117, v13
    v_add_f32 v118, v118, v14
    v_add_f32 v119, v119, v15
    v_lshlrev_b32 v120, 1, v1
    s_lshl4_add_u32 s38, s45, s44
    s_lshl1_add_u32 s38, s38, s36
    s_sub_u32 s38, s38, 6
    s_lshl_b32 s39, s38, 9
    s_add_u32 s39, s39, 0x1384000
    s_mov_b64 exec, 0xffff
    buffer_store_dwordx4 v[112:115], v120, s[24:27], s39 offen sc1
    buffer_store_dwordx4 v[116:119], v120, s[24:27], s39 offen offset:16 sc1
    s_mov_b64 exec, -1
    s_lshl_b32 s38, s38, 7
    s_add_u32 s38, s38, 0x1650000
    s_barrier
    s_load_dword s37, s[18:19], 0
    s_waitcnt vmcnt(0) lgkmcnt(0)
    s_cmp_lg_u32 s37, 0
    s_cbranch_scc1 L_tn_6
    v_mov_b32 v122, 0
    s_mov_b32 s43, 0
L_tag_7:
    global_load_dword v121, v122, s[18:19] sc1
    s_add_u32 s43, s43, 1
    s_waitcnt vmcnt(0)
    v_readfirstlane_b32 s37, v121
    s_cmp_lg_u32 s37, 0
    s_cbranch_scc1 L_tagd_8
    s_cmp_lt_u32 s43, 65536
    s_cbranch_scc1 L_tag_7
L_tagd_8:
L_tn_6:
    v_mov_b32 v121, s37
    s_mov_b64 exec, 0x1
    buffer_store_dword v121, off, s[24:27], s38 sc1
    s_mov_b64 exec, -1
    s_barrier
    s_barrier
    s_barrier
    s_barrier
    s_barrier
L_fr_done:
    v_mov_b32 v6, 108544
    ds_read_b32 v6, v6
    s_mov_b32 s40, 0x1610000
    buffer_load_dword v112, v131, s[24:27], s40 offen sc1
    s_add_u32 s38, s9, 7
    s_and_b32 s38, s38, 7
    s_lshl3_add_u32 s38, s47, s38
    s_mul_i32 s4, s38, 40960
    s_add_u32 s4, s4, 0xd80000
    s_add_u32 s5, s4, s49
    s_add_u32 s4, s4, s48
    s_lshl_b32 s38, s38, 5
    s_add_u32 s38, s38, s46
    s_lshl_b32 s38, s38, 7
    s_add_u32 s6, s38, 0x1670000
    s_waitcnt vmcnt(0) lgkmcnt(0)
    v_readfirstlane_b32 s37, v6
    s_cmp_lt_u32 s36, 4
    s_cselect_b32 s16, 5, 7
    s_add_u32 s16, s16, s37
    s_add_u32 s55, s37, 1
    s_add_u32 s3, s37, 8
    s_barrier
    v_mov_b32 v144, 0
    v_mov_b32 v145, 0
    v_mov_b32 v146, 0
    v_mov_b32 v147, 0
    v_mov_b32 v148, 0
    v_mov_b32 v149, 0
    v_mov_b32 v150, 0
    v_mov_b32 v151, 0
    v_mov_b32 v152, 0
    v_mov_b32 v153, 0
    v_mov_b32 v154, 0
    v_mov_b32 v155, 0
    v_cmp_eq_u32 vcc, 20, v128
    v_writelane_b32 v153, s55, 63
    v_mov_b32 v129, 0x3f803f80
    ds_write_b128 v4, v[144:147] offset:0
    ds_write_b128 v4, v[148:151] offset:1024
    ds_write_b128 v4, v[152:155] offset:2048
    v_cndmask_b32 v129, 0, v129, vcc
    v_mov_b32 v48, v129
    v_mov_b32 v49, v129
    v_mov_b32 v50, v129
    v_mov_b32 v51, v129
    v_mov_b32 v52, v129
    v_mov_b32 v53, v129
    v_mov_b32 v54, v129
    v_mov_b32 v55, v129
    v_mov_b32 v56, v129
    v_mov_b32 v57, v129
    v_mov_b32 v58, v129
    v_mov_b32 v59, v129
    v_mov_b32 v60, v129
    v_mov_b32 v61, v129
    v_mov_b32 v62, v129
    v_mov_b32 v63, v129
    v_mov_b32 v64, v129
    v_mov_b32 v65, v129
    v_mov_b32 v66, v129
    v_mov_b32 v67, v129
    v_mov_b32 v68, v129
    v_mov_b32 v69, v129
    v_mov_b32 v70, v129
    v_mov_b32 v71, v129
    v_mov_b32 v72, v129
    v_mov_b32 v73, v129
    v_mov_b32 v74, v129
    v_mov_b32 v75, v129
    v_mov_b32 v76, v129
    v_mov_b32 v77, v129
    v_mov_b32 v78, v129
    v_mov_b32 v79, v129
    v_mov_b32 v80, v129
    v_mov_b32 v81, v129
    v_mov_b32 v82, v129
    v_mov_b32 v83, v129
    v_mov_b32 v84, v129
    v_mov_b32 v85, v129
    v_mov_b32 v86, v129
    v_mov_b32 v87, v129
    v_mov_b32 v88, v129
    v_mov_b32 v89, v129
    v_mov_b32 v90, v129
    v_mov_b32 v91, v129
    v_mov_b32 v92, v129
    v_mov_b32 v93, v129
    v_mov_b32 v94, v129
    v_mov_b32 v95, v129
    v_mov_b32 v96, v129
    v_mov_b32 v97, v129
    v_mov_b32 v98, v129
    v_mov_b32 v99, v129
    v_mov_b32 v100, v129
    v_mov_b32 v101, v129
    v_mov_b32 v102, v129
    v_mov_b32 v103, v129
    v_mov_b32 v104, v129
    v_mov_b32 v105, v129
    v_mov_b32 v106, v129
    v_mov_b32 v107, v129
    v_mov_b32 v108, v129
    v_mov_b32 v109, v129
    v_mov_b32 v110, v129
    v_mov_b32 v111, v129
    s_cmp_lt_u32 s36, 4
    s_cbranch_scc1 L_att_old
    v_mov_b32 v116, -1
    v_mov_b32 v117, -1
    v_mov_b32 v118, -1
    v_mov_b32 v119, -1
    s_mov_b32 s43, 0
L_aw_9:
    ds_read_b32 v112, v142
    s_add_u32 s43, s43, 1
    s_waitcnt lgkmcnt(0)
    v_cmp_ne_u32 vcc, s37, v112
    s_cmp_eq_u64 vcc, 0
    s_cbranch_scc1 L_awd_10
    s_sleep 2
    s_cmp_lt_u32 s43, 1048576
    s_cbranch_scc1 L_aw_9
L_awd_10:
    ds_read_b128 v[160:163], v2 offset:6144
    ds_read_b128 v[164:167], v2 offset:7168
L_att_old:
    s_setprio 2
    s_mov_b32 s40, 0x1610000
    s_add_u32 s38, s50, s48
    s_add_u32 s39, s50, s49
    s_mov_b32 s43, 0
L_poll_11:
    buffer_load_dword v112, v131, s[24:27], s40 offen sc1
    s_add_u32 s43, s43, 1
    s_waitcnt vmcnt(0)
    v_xor_b32 v112, s37, v112
    v_cmp_ne_u32 vcc, 0, v112
    s_cmp_eq_u64 vcc, 0
    s_cbranch_scc1 L_polld_12
    s_sleep 1
    s_cmp_lt_u32 s43, 65536
    s_cbranch_scc1 L_poll_11
L_polld_12:
    s_cmp_ge_u32 s36, 4
    s_cbranch_scc1 L_att_noq
    buffer_load_dwordx4 v[160:163], v1, s[24:27], s38 offen sc1
    buffer_load_dwordx2 v[112:113], v138, s[24:27], s39 offen sc1
    s_add_u32 s38, s38, 40960
    s_add_u32 s39, s39, 40960
    buffer_load_dwordx4 v[116:119], v1, s[24:27], s38 offen sc1
    buffer_load_dwordx2 v[114:115], v138, s[24:27], s39 offen sc1
L_att_noq:
    s_xor_b32 s38, s47, 0
    s_mul_i32 s38, s38, 40960
    s_add_u32 s39, s38, s51
    buffer_load_dwordx4 v[8:11], v1, s[24:27], s39 offen sc1
    s_add_u32 s39, s38, s17
    buffer_load_dwordx2 v[40:41], v7, s[24:27], s39 offen sc1
    s_add_u32 s39, s38, s52
    s_add_u32 s40, s39, 20480
    s_mov_b64 exec, s[12:13]
    buffer_load_dwordx4 v[48:51], v5, s[24:27], s39 offen sc1
    buffer_load_dwordx4 v[52:55], v5, s[24:27], s40 offen sc1
    s_mov_b64 exec, -1
    s_xor_b32 s38, s47, 1
    s_mul_i32 s38, s38, 40960
    s_add_u32 s39, s38, s51
    buffer_load_dwordx4 v[12:15], v1, s[24:27], s39 offen sc1
    s_add_u32 s39, s38, s52
    s_add_u32 s40, s39, 20480
    s_mov_b64 exec, s[12:13]
    buffer_load_dwordx4 v[56:59], v5, s[24:27], s39 offen sc1
    buffer_load_dwordx4 v[60:63], v5, s[24:27], s40 offen sc1
    s_mov_b64 exec, -1
    s_xor_b32 s38, s47, 2
    s_mul_i32 s38, s38, 40960
    s_add_u32 s39, s38, s51
    buffer_load_dwordx4 v[16:19], v1, s[24:27], s39 offen sc1
    s_add_u32 s39, s38, s17
    buffer_load_dwordx2 v[42:43], v7, s[24:27], s39 offen sc1
    s_add_u32 s39, s38, s52
    s_add_u32 s40, s39, 20480
    s_mov_b64 exec, s[12:13]
    buffer_load_dwordx4 v[64:67], v5, s[24:27], s39 offen sc1
    buffer_load_dwordx4 v[68:71], v5, s[24:27], s40 offen sc1
    s_mov_b64 exec, -1
    s_xor_b32 s38, s47, 3
    s_mul_i32 s38, s38, 40960
    s_add_u32 s39, s38, s51
    buffer_load_dwordx4 v[20:23], v1, s[24:27], s39 offen sc1
    s_add_u32 s39, s38, s52
    s_add_u32 s40, s39, 20480
    s_mov_b64 exec, s[12:13]
    buffer_load_dwordx4 v[72:75], v5, s[24:27], s39 offen sc1
    buffer_load_dwordx4 v[76:79], v5, s[24:27], s40 offen sc1
    s_mov_b64 exec, -1
    s_mov_b64 vcc, -1
    s_cmp_ge_u32 s36, 4
    s_cbranch_scc1 L_att_young
    s_waitcnt vmcnt(12)
    v_cndmask_b32 v164, 0, v112, s[56:57]
    v_cndmask_b32 v165, 0, v113, s[56:57]
    v_cndmask_b32 v166, v112, 0, s[56:57]
    v_cndmask_b32 v167, v113, 0, s[56:57]
    v_cndmask_b32 v120, 0, v114, s[56:57]
    v_cndmask_b32 v121, 0, v115, s[56:57]
    v_cndmask_b32 v122, v114, 0, s[56:57]
    v_cndmask_b32 v123, v115, 0, s[56:57]
    ds_write_b128 v2, v[116:119] offset:14336
    ds_write_b128 v2, v[120:123] offset:15360
    ds_write_b128 v2, v[160:163] offset:6144
    ds_write_b128 v2, v[164:167] offset:7168
    s_nop 0
L_att_hasq:
    v_mfma_f32_32x32x16_bf16 v[112:127], v[8:11], v[160:163], 0
    v_mfma_f32_32x32x8_bf16 v[112:127], v[40:41], v[164:165], v[112:127]
    s_nop 5
    s_branch L_att
L_att_young:
    s_add_u32 s38, s4, 40960
    s_add_u32 s39, s5, 40960
    buffer_store_dwordx4 v[116:119], v1, s[24:27], s4 offen sc1
    buffer_store_dwordx4 v[116:119], v1, s[24:27], s38 offen sc1
    s_mov_b64 exec, s[14:15]
    buffer_store_dwordx2 v[116:117], v1, s[24:27], s5 offen sc1
    buffer_store_dwordx2 v[116:117], v1, s[24:27], s39 offen sc1
    s_mov_b64 exec, -1
    s_waitcnt vmcnt(16) lgkmcnt(0)
    s_branch L_att_hasq
L_att_f0:
    s_xor_b32 s38, s47, 4
    s_mul_i32 s38, s38, 40960
    s_add_u32 s39, s38, s51
    buffer_load_dwordx4 v[24:27], v1, s[24:27], s39 offen sc1
    s_add_u32 s39, s38, s17
    buffer_load_dwordx2 v[44:45], v7, s[24:27], s39 offen sc1
    s_add_u32 s39, s38, s52
    s_add_u32 s40, s39, 20480
    s_mov_b64 exec, s[12:13]
    buffer_load_dwordx4 v[80:83], v5, s[24:27], s39 offen sc1
    buffer_load_dwordx4 v[84:87], v5, s[24:27], s40 offen sc1
    s_mov_b64 exec, -1
    s_xor_b32 s38, s47, 5
    s_mul_i32 s38, s38, 40960
    s_add_u32 s39, s38, s51
    buffer_load_dwordx4 v[28:31], v1, s[24:27], s39 offen sc1
    s_add_u32 s39, s38, s52
    s_add_u32 s40, s39, 20480
    s_mov_b64 exec, s[12:13]
    buffer_load_dwordx4 v[88:91], v5, s[24:27], s39 offen sc1
    buffer_load_dwordx4 v[92:95], v5, s[24:27], s40 offen sc1
    s_mov_b64 exec, -1
    s_xor_b32 s38, s47, 6
    s_mul_i32 s38, s38, 40960
    s_add_u32 s39, s38, s51
    buffer_load_dwordx4 v[32:35], v1, s[24:27], s39 offen sc1
    s_add_u32 s39, s38, s17
    buffer_load_dwordx2 v[46:47], v7, s[24:27], s39 offen sc1
    s_add_u32 s39, s38, s52
    s_add_u32 s40, s39, 20480
    s_mov_b64 exec, s[12:13]
    buffer_load_dwordx4 v[96:99], v5, s[24:27], s39 offen sc1
    buffer_load_dwordx4 v[100:103], v5, s[24:27], s40 offen sc1
    s_mov_b64 exec, -1
    s_xor_b32 s38, s47, 7
    s_mul_i32 s38, s38, 40960
    s_add_u32 s39, s38, s51
    buffer_load_dwordx4 v[36:39], v1, s[24:27], s39 offen sc1
    s_add_u32 s39, s38, s52
    s_add_u32 s40, s39, 20480
    s_mov_b64 exec, s[12:13]
    buffer_load_dwordx4 v[104:107], v5, s[24:27], s39 offen sc1
    buffer_load_dwordx4 v[108:111], v5, s[24:27], s40 offen sc1
    s_mov_b64 exec, -1
    s_lshl_b32 s38, s36, 2
    s_add_u32 s38, s38, 161936
    v_mov_b32 v6, s38
    v_mov_b32 v7, s37
    ds_write_b32 v6, v7
    s_waitcnt vmcnt(19)
    s_branch L_att_r0
L_att_f2:
    s_waitcnt vmcnt(12)
    s_branch L_att_r2
L_att_f4:
    s_waitcnt vmcnt(5)
    s_branch L_att_r4
L_att_f6:
    s_waitcnt vmcnt(0)
    s_setprio 1
    s_cmp_lt_u32 s36, 4
    s_cbranch_scc1 L_att_nomf
    v_lshlrev_b32 v6, 8, v1
    v_mov_b32 v7, s37
    s_mov_b64 exec, 0x3
    buffer_store_dword v7, v6, s[24:27], s6 offen sc1
    s_mov_b64 exec, -1
L_att_nomf:
    v_bfe_u32 v6, v1, 4, 2
    v_lshlrev_b32 v6, 2, v6
    v_add_u32 v6, 161936, v6
    s_mov_b32 s43, 0
L_aw_13:
    ds_read_b32 v7, v6
    s_add_u32 s43, s43, 1
    s_waitcnt lgkmcnt(0)
    v_cmp_ne_u32 vcc, s37, v7
    s_cmp_eq_u64 vcc, 0
    s_cbranch_scc1 L_awd_14
    s_sleep 1
    s_cmp_lt_u32 s43, 1048576
    s_cbranch_scc1 L_aw_13
L_awd_14:
    v_add_u32 v4, 158720, v1
    v_add_u32 v3, s53, v1
    s_mov_b32 s42, s55
    s_sub_u32 s55, s55, 1
    s_mov_b64 vcc, 0
    s_branch L_att_r6
.p2align 6
L_att:
    v_exp_f32 v112, v112
    v_exp_f32 v113, v113
    v_smfmac_f32_32x32x32_bf16 v[144:159], v[108:111], v[136:143], v0
    v_exp_f32 v114, v114
    v_exp_f32 v115, v115
    s_cbranch_vccnz L_att_f0
L_att_r0:
    v_exp_f32 v116, v116
    v_exp_f32 v117, v117
    v_mfma_f32_32x32x16_bf16 v[128:143], v[12:15], v[160:163], 0
    v_exp_f32 v118, v118
    ds_write_b128 v3, v[144:147] offset:0
    v_exp_f32 v119, v119
    ds_write_b128 v3, v[148:151] offset:1024
    v_exp_f32 v120, v120
    v_writelane_b32 v153, s42, 63
    ds_write_b128 v3, v[152:155] offset:2048
    v_exp_f32 v121, v121
    ds_read_b32 v6, v4 offset:3060
    ds_read_b128 v[144:147], v4 offset:0
    ds_read_b128 v[148:151], v4 offset:1024
    ds_read_b128 v[152:155], v4 offset:2048
    v_mfma_f32_32x32x8_bf16 v[128:143], v[40:41], v[166:167], v[128:143]
    v_exp_f32 v122, v122
    v_exp_f32 v123, v123
    v_exp_f32 v124, v124
    v_exp_f32 v125, v125
    v_exp_f32 v126, v126
    v_exp_f32 v127, v127
    v_exp_f32 v128, v128
    v_exp_f32 v129, v129
    v_exp_f32 v130, v130
    v_exp_f32 v131, v131
L_att_chk:
    s_waitcnt lgkmcnt(0)
    v_readfirstlane_b32 s38, v6
    s_cmp_lg_u32 s38, s55
    s_cbranch_scc1 L_att_retry
L_att_go:
    v_smfmac_f32_32x32x32_bf16 v[144:159], v[48:51], v[112:119], v0
    v_exp_f32 v132, v132
    v_exp_f32 v133, v133
    v_exp_f32 v134, v134
    v_smfmac_f32_32x32x32_bf16 v[144:159], v[52:55], v[120:127], v0
    v_exp_f32 v135, v135
    v_exp_f32 v136, v136
    v_exp_f32 v137, v137
    v_mfma_f32_32x32x16_bf16 v[112:127], v[16:19], v[160:163], 0
    v_exp_f32 v138, v138
    v_exp_f32 v139, v139
    v_exp_f32 v140, v140
    v_mfma_f32_32x32x8_bf16 v[112:127], v[42:43], v[164:165], v[112:127]
    v_exp_f32 v141, v141
    v_exp_f32 v142, v142
    v_exp_f32 v143, v143
    v_smfmac_f32_32x32x32_bf16 v[144:159], v[56:59], v[128:135], v0
    v_exp_f32 v112, v112
    v_exp_f32 v113, v113
    v_exp_f32 v114, v114
    v_smfmac_f32_32x32x32_bf16 v[144:159], v[60:63], v[136:143], v0
    v_exp_f32 v115, v115
    s_cbranch_vccnz L_att_f2
L_att_r2:
    v_exp_f32 v116, v116
    v_exp_f32 v117, v117
    v_exp_f32 v118, v118
    v_mfma_f32_32x32x16_bf16 v[128:143], v[20:23], v[160:163], 0
    v_exp_f32 v119, v119
    v_exp_f32 v120, v120
    v_exp_f32 v121, v121
    v_exp_f32 v122, v122
    v_mfma_f32_32x32x8_bf16 v[128:143], v[42:43], v[166:167], v[128:143]
    v_exp_f32 v123, v123
    v_exp_f32 v124, v124
    v_exp_f32 v125, v125
    v_exp_f32 v126, v126
    v_smfmac_f32_32x32x32_bf16 v[144:159], v[64:67], v[112:119], v0
    v_exp_f32 v127, v127
    v_exp_f32 v128, v128
    v_exp_f32 v129, v129
    v_smfmac_f32_32x32x32_bf16 v[144:159], v[68:71], v[120:127], v0
    v_exp_f32 v130, v130
    v_exp_f32 v131, v131
    v_exp_f32 v132, v132
    v_add_u16 v3, 0x2000, v3
    s_add_u32 s42, s55, 2
    v_exp_f32 v133, v133
    v_mfma_f32_32x32x16_bf16 v[112:127], v[24:27], v[160:163], 0
    v_exp_f32 v134, v134
    v_exp_f32 v135, v135
    v_exp_f32 v136, v136
    v_add_u16 v4, 0x2000, v3
    s_add_u32 s55, s55, 1
    v_exp_f32 v137, v137
    v_mfma_f32_32x32x8_bf16 v[112:127], v[44:45], v[164:165], v[112:127]
    v_exp_f32 v138, v138
    v_exp_f32 v139, v139
    v_exp_f32 v140, v140
    v_exp_f32 v141, v141
    v_smfmac_f32_32x32x32_bf16 v[144:159], v[72:75], v[128:135], v0
    v_exp_f32 v142, v142
    v_exp_f32 v143, v143
    v_exp_f32 v112, v112
    v_exp_f32 v113, v113
    v_smfmac_f32_32x32x32_bf16 v[144:159], v[76:79], v[136:143], v0
    v_exp_f32 v114, v114
    v_exp_f32 v115, v115
    s_cbranch_vccnz L_att_f4
L_att_r4:
    v_exp_f32 v116, v116
    v_exp_f32 v117, v117
    v_mfma_f32_32x32x16_bf16 v[128:143], v[28:31], v[160:163], 0
    v_exp_f32 v118, v118
    v_exp_f32 v119, v119
    v_exp_f32 v120, v120
    v_exp_f32 v121, v121
    v_mfma_f32_32x32x8_bf16 v[128:143], v[44:45], v[166:167], v[128:143]
    v_exp_f32 v122, v122
    v_exp_f32 v123, v123
    v_exp_f32 v124, v124
    v_exp_f32 v125, v125
    v_smfmac_f32_32x32x32_bf16 v[144:159], v[80:83], v[112:119], v0
    v_exp_f32 v126, v126
    v_exp_f32 v127, v127
    v_exp_f32 v128, v128
    v_exp_f32 v129, v129
    v_smfmac_f32_32x32x32_bf16 v[144:159], v[84:87], v[120:127], v0
    v_exp_f32 v130, v130
    v_exp_f32 v131, v131
    v_exp_f32 v132, v132
    v_exp_f32 v133, v133
    v_mfma_f32_32x32x16_bf16 v[112:127], v[32:35], v[160:163], 0
    v_exp_f32 v134, v134
    v_exp_f32 v135, v135
    v_exp_f32 v136, v136
    v_add_u16 v2, 0x2000, v2
    v_exp_f32 v137, v137
    v_mfma_f32_32x32x8_bf16 v[112:127], v[46:47], v[164:165], v[112:127]
    v_exp_f32 v138, v138
    v_exp_f32 v139, v139
    v_exp_f32 v140, v140
    v_exp_f32 v141, v141
    v_smfmac_f32_32x32x32_bf16 v[144:159], v[88:91], v[128:135], v0
    v_exp_f32 v142, v142
    v_exp_f32 v143, v143
    v_exp_f32 v112, v112
    v_exp_f32 v113, v113
    v_smfmac_f32_32x32x32_bf16 v[144:159], v[92:95], v[136:143], v0
    v_exp_f32 v114, v114
    v_exp_f32 v115, v115
    s_cbranch_vccnz L_att_f6
L_att_r6:
    v_exp_f32 v116, v116
    v_exp_f32 v117, v117
    v_mfma_f32_32x32x16_bf16 v[128:143], v[36:39], v[160:163], 0
    v_exp_f32 v118, v118
    v_exp_f32 v119, v119
    v_exp_f32 v120, v120
    v_exp_f32 v121, v121
    v_mfma_f32_32x32x8_bf16 v[128:143], v[46:47], v[166:167], v[128:143]
    v_exp_f32 v122, v122
    v_exp_f32 v123, v123
    ds_read_b128 v[160:163], v2 offset:6144
    ds_read_b128 v[164:167], v2 offset:7168
    v_exp_f32 v124, v124
    v_exp_f32 v125, v125
    v_smfmac_f32_32x32x32_bf16 v[144:159], v[96:99], v[112:119], v0
    v_exp_f32 v126, v126
    v_exp_f32 v127, v127
    v_exp_f32 v128, v128
    v_exp_f32 v129, v129
    v_smfmac_f32_32x32x32_bf16 v[144:159], v[100:103], v[120:127], v0
    v_exp_f32 v130, v130
    v_exp_f32 v131, v131
    v_exp_f32 v132, v132
    v_exp_f32 v133, v133
    s_waitcnt lgkmcnt(0)
    v_mfma_f32_32x32x16_bf16 v[112:127], v[8:11], v[160:163], 0
    v_exp_f32 v134, v134
    v_exp_f32 v135, v135
    v_exp_f32 v136, v136
    v_exp_f32 v137, v137
    v_mfma_f32_32x32x8_bf16 v[112:127], v[40:41], v[164:165], v[112:127]
    v_exp_f32 v138, v138
    v_exp_f32 v139, v139
    v_exp_f32 v140, v140
    v_exp_f32 v141, v141
    v_smfmac_f32_32x32x32_bf16 v[144:159], v[104:107], v[128:135], v0
    v_exp_f32 v142, v142
    v_exp_f32 v143, v143
    s_cmp_lg_u32 s55, s16
    s_cbranch_scc1 L_att
    s_cmp_eq_u32 s55, s3
    s_cbranch_scc1 L_att_out
    s_mov_b32 s16, s3
    s_setprio 0
    s_branch L_att
L_att_out:
    v_smfmac_f32_32x32x32_bf16 v[144:159], v[108:111], v[136:143], v0
    s_cmp_lt_u32 s36, 4
    s_cselect_b32 s38, 1, -1
    s_mul_i32 s38, s38, 3072
    v_add_u32 v4, s38, v3
    s_add_u32 s9, s9, 7
    s_and_b32 s9, s9, 7
    s_mov_b32 s43, 0
L_att_fin:
    ds_read_b32 v6, v4 offset:3060
    ds_read_b128 v[112:115], v4 offset:0
    ds_read_b128 v[116:119], v4 offset:1024
    ds_read_b128 v[120:123], v4 offset:2048
    s_mov_b32 s39, 0x30800000
    s_mov_b32 s40, 0x5d800000
    s_add_u32 s43, s43, 1
    s_waitcnt lgkmcnt(0)
    v_readfirstlane_b32 s38, v6
    s_cmp_eq_u32 s38, s3
    s_cbranch_scc1 L_att_sum
    s_sleep 1
    s_cmp_lt_u32 s43, 1048576
    s_cbranch_scc1 L_att_fin
L_att_sum:
    v_add_f32 v124, v120, v152
    v_add_f32 v125, v120, v152
    v_add_f32 v112, v112, v144
    v_add_f32 v113, v113, v145
    v_permlane32_swap_b32 v125, v124
    v_add_f32 v114, v114, v146
    v_rcp_f32 v125, v124
    v_add_f32 v115, v115, v147
    v_add_f32 v116, v116, v148
    v_add_f32 v117, v117, v149
    v_add_f32 v118, v118, v150
    v_add_f32 v119, v119, v151
    v_add_f32 v120, v120, v152
    v_add_f32 v121, v121, v153
    v_add_f32 v122, v122, v154
    v_add_f32 v123, v123, v155
    v_mul_f32 v144, v125, v112
    v_fma_f32 v124, v112, 0, v124
    v_mul_f32 v145, v125, v113
    v_fma_f32 v124, v113, 0, v124
    v_mul_f32 v146, v125, v114
    v_fma_f32 v124, v114, 0, v124
    v_mul_f32 v147, v125, v115
    v_fma_f32 v124, v115, 0, v124
    v_mul_f32 v148, v125, v116
    v_fma_f32 v124, v116, 0, v124
    v_mul_f32 v149, v125, v117
    v_fma_f32 v124, v117, 0, v124
    v_mul_f32 v150, v125, v118
    v_fma_f32 v124, v118, 0, v124
    v_mul_f32 v151, v125, v119
    v_fma_f32 v124, v119, 0, v124
    v_mul_f32 v152, v125, v120
    v_fma_f32 v124, v120, 0, v124
    v_mul_f32 v153, v125, v121
    v_fma_f32 v124, v121, 0, v124
    v_mul_f32 v154, v125, v122
    v_fma_f32 v124, v122, 0, v124
    v_mul_f32 v155, v125, v123
    v_fma_f32 v124, v123, 0, v124
    v_cmp_nle_f32 vcc, s39, v124
    v_cmp_nge_f32 s[58:59], s40, v124
    v_cvt_pk_bf16_f32 v160, v144, v145
    v_cvt_pk_bf16_f32 v161, v146, v147
    v_cvt_pk_bf16_f32 v162, v148, v149
    v_cvt_pk_bf16_f32 v163, v150, v151
    v_cvt_pk_bf16_f32 v164, v152, v153
    v_cvt_pk_bf16_f32 v165, v154, v155
    s_or_b64 vcc, vcc, s[58:59]
    s_cselect_b32 s8, 1, 0
    s_andn2_b32 s8, s8, s54
    s_cbranch_scc1 L_att_nopub
    buffer_store_dwordx4 v[160:163], v1, s[24:27], s4 offen sc1
    s_mov_b64 exec, s[14:15]
    buffer_store_dwordx2 v[164:165], v1, s[24:27], s5 offen sc1
    s_mov_b64 exec, -1
    s_cmp_lg_u32 s54, 0
    s_cbranch_scc1 L_att_end
L_att_nopub:
    s_lshl_b32 s38, s36, 2
    s_add_u32 s38, s38, 161968
    v_mov_b32 v6, s38
    s_add_u32 s39, s37, s8
    v_mov_b32 v7, s39
    s_waitcnt lgkmcnt(0)
    ds_write_b32 v6, v7
    v_bfe_u32 v6, v1, 4, 3
    v_lshlrev_b32 v6, 2, v6
    v_add_u32 v6, 161968, v6
    s_mov_b32 s43, 0
L_ga_15:
    ds_read_b32 v7, v6
    s_add_u32 s43, s43, 1
    s_waitcnt lgkmcnt(0)
    v_subrev_u32 v7, s37, v7
    v_cmp_lt_u32 vcc, 1, v7
    s_cmp_eq_u64 vcc, 0
    s_cbranch_scc1 L_gad_16
    s_sleep 4
    s_cmp_lt_u32 s43, 1048576
    s_cbranch_scc1 L_ga_15
L_gad_16:
    v_cmp_eq_u32 vcc, 1, v7
    s_cmp_lg_u64 vcc, 0
    s_cbranch_scc1 L_att_fb
L_att_end:
    s_endpgm
L_att_retry:
    s_add_u32 s43, s43, 1
    s_cmp_ge_u32 s43, 1048576
    s_cbranch_scc1 L_att_go
    s_sleep 1
    ds_read_b32 v6, v4 offset:3060
    ds_read_b128 v[144:147], v4 offset:0
    ds_read_b128 v[148:151], v4 offset:1024
    ds_read_b128 v[152:155], v4 offset:2048
    s_branch L_att_chk
L_att_fb:
    v_mov_b32 v144, 0
    v_mov_b32 v145, 0
    v_mov_b32 v146, 0
    v_mov_b32 v147, 0
    v_mov_b32 v148, 0
    v_mov_b32 v149, 0
    v_mov_b32 v150, 0
    v_mov_b32 v151, 0
    v_mov_b32 v152, 0
    v_mov_b32 v153, 0
    v_mov_b32 v154, 0
    v_mov_b32 v155, 0
    v_mov_b32 v156, 0
    v_mov_b32 v157, 0
    v_mov_b32 v158, 0
    v_mov_b32 v159, 0
    s_lshl_b32 s38, s36, 13
    v_add_u32 v4, s38, v1
    ds_write_b128 v4, v[144:147] offset:0
    ds_write_b128 v4, v[144:147] offset:1024
    ds_write_b128 v4, v[144:147] offset:2048
    v_bfe_u32 v5, v1, 4, 5
    v_lshlrev_b32 v5, 2, v5
    v_add_u32 v5, 65536, v5
    s_lshl_b32 s38, s36, 7
    v_add_u32 v3, s38, v5
    v_mov_b32 v7, 0xff800000
    ds_write_b32 v3, v7
    s_lshl_b32 s38, s36, 2
    s_add_u32 s38, s38, 162000
    v_mov_b32 v6, s38
    v_mov_b32 v7, s37
    s_waitcnt lgkmcnt(0)
    ds_write_b32 v6, v7
    v_bfe_u32 v6, v1, 4, 3
    v_lshlrev_b32 v6, 2, v6
    v_add_u32 v6, 162000, v6
    s_mov_b32 s43, 0
L_ga_17:
    ds_read_b32 v7, v6
    s_add_u32 s43, s43, 1
    s_waitcnt lgkmcnt(0)
    v_subrev_u32 v7, s37, v7
    v_cmp_lt_u32 vcc, 1, v7
    s_cmp_eq_u64 vcc, 0
    s_cbranch_scc1 L_gad_18
    s_sleep 4
    s_cmp_lt_u32 s43, 1048576
    s_cbranch_scc1 L_ga_17
L_gad_18:
    s_mov_b32 s42, 0
    v_add_u32 v2, 6144, v1
    v_mov_b32 v4, v1
    v_mov_b32 v3, v5
L_fb0:
    ds_read_b128 v[160:163], v2
    ds_read_b128 v[164:167], v2 offset:1024
    v_mov_b32 v7, 0xff800000
    s_waitcnt lgkmcnt(0)
    v_mfma_f32_32x32x16_bf16 v[112:127], v[8:11], v[160:163], 0
    v_mfma_f32_32x32x8_bf16 v[112:127], v[40:41], v[164:165], v[112:127]
    s_nop 11
    v_max3_f32 v7, v112, v113, v7
    v_max3_f32 v7, v114, v115, v7
    v_max3_f32 v7, v116, v117, v7
    v_max3_f32 v7, v118, v119, v7
    v_max3_f32 v7, v120, v121, v7
    v_max3_f32 v7, v122, v123, v7
    v_max3_f32 v7, v124, v125, v7
    v_max3_f32 v7, v126, v127, v7
    v_mfma_f32_32x32x16_bf16 v[112:127], v[12:15], v[160:163], 0
    v_mfma_f32_32x32x8_bf16 v[112:127], v[40:41], v[166:167], v[112:127]
    s_nop 11
    v_max3_f32 v7, v112, v113, v7
    v_max3_f32 v7, v114, v115, v7
    v_max3_f32 v7, v116, v117, v7
    v_max3_f32 v7, v118, v119, v7
    v_max3_f32 v7, v120, v121, v7
    v_max3_f32 v7, v122, v123, v7
    v_max3_f32 v7, v124, v125, v7
    v_max3_f32 v7, v126, v127, v7
    v_mfma_f32_32x32x16_bf16 v[112:127], v[16:19], v[160:163], 0
    v_mfma_f32_32x32x8_bf16 v[112:127], v[42:43], v[164:165], v[112:127]
    s_nop 11
    v_max3_f32 v7, v112, v113, v7
    v_max3_f32 v7, v114, v115, v7
    v_max3_f32 v7, v116, v117, v7
    v_max3_f32 v7, v118, v119, v7
    v_max3_f32 v7, v120, v121, v7
    v_max3_f32 v7, v122, v123, v7
    v_max3_f32 v7, v124, v125, v7
    v_max3_f32 v7, v126, v127, v7
    v_mfma_f32_32x32x16_bf16 v[112:127], v[20:23], v[160:163], 0
    v_mfma_f32_32x32x8_bf16 v[112:127], v[42:43], v[166:167], v[112:127]
    s_nop 11
    v_max3_f32 v7, v112, v113, v7
    v_max3_f32 v7, v114, v115, v7
    v_max3_f32 v7, v116, v117, v7
    v_max3_f32 v7, v118, v119, v7
    v_max3_f32 v7, v120, v121, v7
    v_max3_f32 v7, v122, v123, v7
    v_max3_f32 v7, v124, v125, v7
    v_max3_f32 v7, v126, v127, v7
    v_mfma_f32_32x32x16_bf16 v[112:127], v[24:27], v[160:163], 0
    v_mfma_f32_32x32x8_bf16 v[112:127], v[44:45], v[164:165], v[112:127]
    s_nop 11
    v_max3_f32 v7, v112, v113, v7
    v_max3_f32 v7, v114, v115, v7
    v_max3_f32 v7, v116, v117, v7
    v_max3_f32 v7, v118, v119, v7
    v_max3_f32 v7, v120, v121, v7
    v_max3_f32 v7, v122, v123, v7
    v_max3_f32 v7, v124, v125, v7
    v_max3_f32 v7, v126, v127, v7
    v_mfma_f32_32x32x16_bf16 v[112:127], v[28:31], v[160:163], 0
    v_mfma_f32_32x32x8_bf16 v[112:127], v[44:45], v[166:167], v[112:127]
    s_nop 11
    v_max3_f32 v7, v112, v113, v7
    v_max3_f32 v7, v114, v115, v7
    v_max3_f32 v7, v116, v117, v7
    v_max3_f32 v7, v118, v119, v7
    v_max3_f32 v7, v120, v121, v7
    v_max3_f32 v7, v122, v123, v7
    v_max3_f32 v7, v124, v125, v7
    v_max3_f32 v7, v126, v127, v7
    v_mfma_f32_32x32x16_bf16 v[112:127], v[32:35], v[160:163], 0
    v_mfma_f32_32x32x8_bf16 v[112:127], v[46:47], v[164:165], v[112:127]
    s_nop 11
    v_max3_f32 v7, v112, v113, v7
    v_max3_f32 v7, v114, v115, v7
    v_max3_f32 v7, v116, v117, v7
    v_max3_f32 v7, v118, v119, v7
    v_max3_f32 v7, v120, v121, v7
    v_max3_f32 v7, v122, v123, v7
    v_max3_f32 v7, v124, v125, v7
    v_max3_f32 v7, v126, v127, v7
    v_mfma_f32_32x32x16_bf16 v[112:127], v[36:39], v[160:163], 0
    v_mfma_f32_32x32x8_bf16 v[112:127], v[46:47], v[166:167], v[112:127]
    s_nop 11
    v_max3_f32 v7, v112, v113, v7
    v_max3_f32 v7, v114, v115, v7
    v_max3_f32 v7, v116, v117, v7
    v_max3_f32 v7, v118, v119, v7
    v_max3_f32 v7, v120, v121, v7
    v_max3_f32 v7, v122, v123, v7
    v_max3_f32 v7, v124, v125, v7
    v_max3_f32 v7, v126, v127, v7
    ds_max_f32 v3, v7
    v_add_u32 v2, 8192, v2
    v_add_u32 v4, 8192, v4
    v_add_u32 v3, 128, v3
    s_add_u32 s42, s42, 1
    s_cmp_lt_u32 s42, 8
    s_cbranch_scc1 L_fb0
    s_lshl_b32 s38, s36, 2
    s_add_u32 s38, s38, 162032
    v_mov_b32 v6, s38
    v_mov_b32 v7, s37
    s_waitcnt lgkmcnt(0)
    ds_write_b32 v6, v7
    v_bfe_u32 v6, v1, 4, 3
    v_lshlrev_b32 v6, 2, v6
    v_add_u32 v6, 162032, v6
    s_mov_b32 s43, 0
L_ga_19:
    ds_read_b32 v7, v6
    s_add_u32 s43, s43, 1
    s_waitcnt lgkmcnt(0)
    v_subrev_u32 v7, s37, v7
    v_cmp_lt_u32 vcc, 1, v7
    s_cmp_eq_u64 vcc, 0
    s_cbranch_scc1 L_gad_20
    s_sleep 4
    s_cmp_lt_u32 s43, 1048576
    s_cbranch_scc1 L_ga_19
L_gad_20:
    s_mov_b32 s42, 0
    v_add_u32 v2, 6144, v1
    v_mov_b32 v4, v1
    v_mov_b32 v3, v5
L_fb1:
    ds_read_b128 v[160:163], v2
    ds_read_b128 v[164:167], v2 offset:1024
    ds_read_b32 v7, v3
    s_waitcnt lgkmcnt(0)
    v_mfma_f32_32x32x16_bf16 v[112:127], v[8:11], v[160:163], 0
    v_mfma_f32_32x32x8_bf16 v[112:127], v[40:41], v[164:165], v[112:127]
    s_nop 11
    v_sub_f32 v112, v112, v7
    v_sub_f32 v113, v113, v7
    v_sub_f32 v114, v114, v7
    v_sub_f32 v115, v115, v7
    v_sub_f32 v116, v116, v7
    v_sub_f32 v117, v117, v7
    v_sub_f32 v118, v118, v7
    v_sub_f32 v119, v119, v7
    v_sub_f32 v120, v120, v7
    v_sub_f32 v121, v121, v7
    v_sub_f32 v122, v122, v7
    v_sub_f32 v123, v123, v7
    v_sub_f32 v124, v124, v7
    v_sub_f32 v125, v125, v7
    v_sub_f32 v126, v126, v7
    v_sub_f32 v127, v127, v7
    v_exp_f32 v112, v112
    v_exp_f32 v113, v113
    v_exp_f32 v114, v114
    v_exp_f32 v115, v115
    v_exp_f32 v116, v116
    v_exp_f32 v117, v117
    v_exp_f32 v118, v118
    v_exp_f32 v119, v119
    v_exp_f32 v120, v120
    v_exp_f32 v121, v121
    v_exp_f32 v122, v122
    v_exp_f32 v123, v123
    v_exp_f32 v124, v124
    v_exp_f32 v125, v125
    v_exp_f32 v126, v126
    v_exp_f32 v127, v127
    s_nop 1
    v_smfmac_f32_32x32x32_bf16 v[144:159], v[48:51], v[112:119], v0
    v_smfmac_f32_32x32x32_bf16 v[144:159], v[52:55], v[120:127], v0
    v_mfma_f32_32x32x16_bf16 v[112:127], v[12:15], v[160:163], 0
    v_mfma_f32_32x32x8_bf16 v[112:127], v[40:41], v[166:167], v[112:127]
    s_nop 11
    v_sub_f32 v112, v112, v7
    v_sub_f32 v113, v113, v7
    v_sub_f32 v114, v114, v7
    v_sub_f32 v115, v115, v7
    v_sub_f32 v116, v116, v7
    v_sub_f32 v117, v117, v7
    v_sub_f32 v118, v118, v7
    v_sub_f32 v119, v119, v7
    v_sub_f32 v120, v120, v7
    v_sub_f32 v121, v121, v7
    v_sub_f32 v122, v122, v7
    v_sub_f32 v123, v123, v7
    v_sub_f32 v124, v124, v7
    v_sub_f32 v125, v125, v7
    v_sub_f32 v126, v126, v7
    v_sub_f32 v127, v127, v7
    v_exp_f32 v112, v112
    v_exp_f32 v113, v113
    v_exp_f32 v114, v114
    v_exp_f32 v115, v115
    v_exp_f32 v116, v116
    v_exp_f32 v117, v117
    v_exp_f32 v118, v118
    v_exp_f32 v119, v119
    v_exp_f32 v120, v120
    v_exp_f32 v121, v121
    v_exp_f32 v122, v122
    v_exp_f32 v123, v123
    v_exp_f32 v124, v124
    v_exp_f32 v125, v125
    v_exp_f32 v126, v126
    v_exp_f32 v127, v127
    s_nop 1
    v_smfmac_f32_32x32x32_bf16 v[144:159], v[56:59], v[112:119], v0
    v_smfmac_f32_32x32x32_bf16 v[144:159], v[60:63], v[120:127], v0
    v_mfma_f32_32x32x16_bf16 v[112:127], v[16:19], v[160:163], 0
    v_mfma_f32_32x32x8_bf16 v[112:127], v[42:43], v[164:165], v[112:127]
    s_nop 11
    v_sub_f32 v112, v112, v7
    v_sub_f32 v113, v113, v7
    v_sub_f32 v114, v114, v7
    v_sub_f32 v115, v115, v7
    v_sub_f32 v116, v116, v7
    v_sub_f32 v117, v117, v7
    v_sub_f32 v118, v118, v7
    v_sub_f32 v119, v119, v7
    v_sub_f32 v120, v120, v7
    v_sub_f32 v121, v121, v7
    v_sub_f32 v122, v122, v7
    v_sub_f32 v123, v123, v7
    v_sub_f32 v124, v124, v7
    v_sub_f32 v125, v125, v7
    v_sub_f32 v126, v126, v7
    v_sub_f32 v127, v127, v7
    v_exp_f32 v112, v112
    v_exp_f32 v113, v113
    v_exp_f32 v114, v114
    v_exp_f32 v115, v115
    v_exp_f32 v116, v116
    v_exp_f32 v117, v117
    v_exp_f32 v118, v118
    v_exp_f32 v119, v119
    v_exp_f32 v120, v120
    v_exp_f32 v121, v121
    v_exp_f32 v122, v122
    v_exp_f32 v123, v123
    v_exp_f32 v124, v124
    v_exp_f32 v125, v125
    v_exp_f32 v126, v126
    v_exp_f32 v127, v127
    s_nop 1
    v_smfmac_f32_32x32x32_bf16 v[144:159], v[64:67], v[112:119], v0
    v_smfmac_f32_32x32x32_bf16 v[144:159], v[68:71], v[120:127], v0
    v_mfma_f32_32x32x16_bf16 v[112:127], v[20:23], v[160:163], 0
    v_mfma_f32_32x32x8_bf16 v[112:127], v[42:43], v[166:167], v[112:127]
    s_nop 11
    v_sub_f32 v112, v112, v7
    v_sub_f32 v113, v113, v7
    v_sub_f32 v114, v114, v7
    v_sub_f32 v115, v115, v7
    v_sub_f32 v116, v116, v7
    v_sub_f32 v117, v117, v7
    v_sub_f32 v118, v118, v7
    v_sub_f32 v119, v119, v7
    v_sub_f32 v120, v120, v7
    v_sub_f32 v121, v121, v7
    v_sub_f32 v122, v122, v7
    v_sub_f32 v123, v123, v7
    v_sub_f32 v124, v124, v7
    v_sub_f32 v125, v125, v7
    v_sub_f32 v126, v126, v7
    v_sub_f32 v127, v127, v7
    v_exp_f32 v112, v112
    v_exp_f32 v113, v113
    v_exp_f32 v114, v114
    v_exp_f32 v115, v115
    v_exp_f32 v116, v116
    v_exp_f32 v117, v117
    v_exp_f32 v118, v118
    v_exp_f32 v119, v119
    v_exp_f32 v120, v120
    v_exp_f32 v121, v121
    v_exp_f32 v122, v122
    v_exp_f32 v123, v123
    v_exp_f32 v124, v124
    v_exp_f32 v125, v125
    v_exp_f32 v126, v126
    v_exp_f32 v127, v127
    s_nop 1
    v_smfmac_f32_32x32x32_bf16 v[144:159], v[72:75], v[112:119], v0
    v_smfmac_f32_32x32x32_bf16 v[144:159], v[76:79], v[120:127], v0
    v_mfma_f32_32x32x16_bf16 v[112:127], v[24:27], v[160:163], 0
    v_mfma_f32_32x32x8_bf16 v[112:127], v[44:45], v[164:165], v[112:127]
    s_nop 11
    v_sub_f32 v112, v112, v7
    v_sub_f32 v113, v113, v7
    v_sub_f32 v114, v114, v7
    v_sub_f32 v115, v115, v7
    v_sub_f32 v116, v116, v7
    v_sub_f32 v117, v117, v7
    v_sub_f32 v118, v118, v7
    v_sub_f32 v119, v119, v7
    v_sub_f32 v120, v120, v7
    v_sub_f32 v121, v121, v7
    v_sub_f32 v122, v122, v7
    v_sub_f32 v123, v123, v7
    v_sub_f32 v124, v124, v7
    v_sub_f32 v125, v125, v7
    v_sub_f32 v126, v126, v7
    v_sub_f32 v127, v127, v7
    v_exp_f32 v112, v112
    v_exp_f32 v113, v113
    v_exp_f32 v114, v114
    v_exp_f32 v115, v115
    v_exp_f32 v116, v116
    v_exp_f32 v117, v117
    v_exp_f32 v118, v118
    v_exp_f32 v119, v119
    v_exp_f32 v120, v120
    v_exp_f32 v121, v121
    v_exp_f32 v122, v122
    v_exp_f32 v123, v123
    v_exp_f32 v124, v124
    v_exp_f32 v125, v125
    v_exp_f32 v126, v126
    v_exp_f32 v127, v127
    s_nop 1
    v_smfmac_f32_32x32x32_bf16 v[144:159], v[80:83], v[112:119], v0
    v_smfmac_f32_32x32x32_bf16 v[144:159], v[84:87], v[120:127], v0
    v_mfma_f32_32x32x16_bf16 v[112:127], v[28:31], v[160:163], 0
    v_mfma_f32_32x32x8_bf16 v[112:127], v[44:45], v[166:167], v[112:127]
    s_nop 11
    v_sub_f32 v112, v112, v7
    v_sub_f32 v113, v113, v7
    v_sub_f32 v114, v114, v7
    v_sub_f32 v115, v115, v7
    v_sub_f32 v116, v116, v7
    v_sub_f32 v117, v117, v7
    v_sub_f32 v118, v118, v7
    v_sub_f32 v119, v119, v7
    v_sub_f32 v120, v120, v7
    v_sub_f32 v121, v121, v7
    v_sub_f32 v122, v122, v7
    v_sub_f32 v123, v123, v7
    v_sub_f32 v124, v124, v7
    v_sub_f32 v125, v125, v7
    v_sub_f32 v126, v126, v7
    v_sub_f32 v127, v127, v7
    v_exp_f32 v112, v112
    v_exp_f32 v113, v113
    v_exp_f32 v114, v114
    v_exp_f32 v115, v115
    v_exp_f32 v116, v116
    v_exp_f32 v117, v117
    v_exp_f32 v118, v118
    v_exp_f32 v119, v119
    v_exp_f32 v120, v120
    v_exp_f32 v121, v121
    v_exp_f32 v122, v122
    v_exp_f32 v123, v123
    v_exp_f32 v124, v124
    v_exp_f32 v125, v125
    v_exp_f32 v126, v126
    v_exp_f32 v127, v127
    s_nop 1
    v_smfmac_f32_32x32x32_bf16 v[144:159], v[88:91], v[112:119], v0
    v_smfmac_f32_32x32x32_bf16 v[144:159], v[92:95], v[120:127], v0
    v_mfma_f32_32x32x16_bf16 v[112:127], v[32:35], v[160:163], 0
    v_mfma_f32_32x32x8_bf16 v[112:127], v[46:47], v[164:165], v[112:127]
    s_nop 11
    v_sub_f32 v112, v112, v7
    v_sub_f32 v113, v113, v7
    v_sub_f32 v114, v114, v7
    v_sub_f32 v115, v115, v7
    v_sub_f32 v116, v116, v7
    v_sub_f32 v117, v117, v7
    v_sub_f32 v118, v118, v7
    v_sub_f32 v119, v119, v7
    v_sub_f32 v120, v120, v7
    v_sub_f32 v121, v121, v7
    v_sub_f32 v122, v122, v7
    v_sub_f32 v123, v123, v7
    v_sub_f32 v124, v124, v7
    v_sub_f32 v125, v125, v7
    v_sub_f32 v126, v126, v7
    v_sub_f32 v127, v127, v7
    v_exp_f32 v112, v112
    v_exp_f32 v113, v113
    v_exp_f32 v114, v114
    v_exp_f32 v115, v115
    v_exp_f32 v116, v116
    v_exp_f32 v117, v117
    v_exp_f32 v118, v118
    v_exp_f32 v119, v119
    v_exp_f32 v120, v120
    v_exp_f32 v121, v121
    v_exp_f32 v122, v122
    v_exp_f32 v123, v123
    v_exp_f32 v124, v124
    v_exp_f32 v125, v125
    v_exp_f32 v126, v126
    v_exp_f32 v127, v127
    s_nop 1
    v_smfmac_f32_32x32x32_bf16 v[144:159], v[96:99], v[112:119], v0
    v_smfmac_f32_32x32x32_bf16 v[144:159], v[100:103], v[120:127], v0
    v_mfma_f32_32x32x16_bf16 v[112:127], v[36:39], v[160:163], 0
    v_mfma_f32_32x32x8_bf16 v[112:127], v[46:47], v[166:167], v[112:127]
    s_nop 11
    v_sub_f32 v112, v112, v7
    v_sub_f32 v113, v113, v7
    v_sub_f32 v114, v114, v7
    v_sub_f32 v115, v115, v7
    v_sub_f32 v116, v116, v7
    v_sub_f32 v117, v117, v7
    v_sub_f32 v118, v118, v7
    v_sub_f32 v119, v119, v7
    v_sub_f32 v120, v120, v7
    v_sub_f32 v121, v121, v7
    v_sub_f32 v122, v122, v7
    v_sub_f32 v123, v123, v7
    v_sub_f32 v124, v124, v7
    v_sub_f32 v125, v125, v7
    v_sub_f32 v126, v126, v7
    v_sub_f32 v127, v127, v7
    v_exp_f32 v112, v112
    v_exp_f32 v113, v113
    v_exp_f32 v114, v114
    v_exp_f32 v115, v115
    v_exp_f32 v116, v116
    v_exp_f32 v117, v117
    v_exp_f32 v118, v118
    v_exp_f32 v119, v119
    v_exp_f32 v120, v120
    v_exp_f32 v121, v121
    v_exp_f32 v122, v122
    v_exp_f32 v123, v123
    v_exp_f32 v124, v124
    v_exp_f32 v125, v125
    v_exp_f32 v126, v126
    v_exp_f32 v127, v127
    s_nop 1
    v_smfmac_f32_32x32x32_bf16 v[144:159], v[104:107], v[112:119], v0
    v_smfmac_f32_32x32x32_bf16 v[144:159], v[108:111], v[120:127], v0
    s_nop 11
    ds_add_f32 v4, v144 offset:0
    ds_add_f32 v4, v145 offset:4
    ds_add_f32 v4, v146 offset:8
    ds_add_f32 v4, v147 offset:12
    ds_add_f32 v4, v148 offset:1024
    ds_add_f32 v4, v149 offset:1028
    ds_add_f32 v4, v150 offset:1032
    ds_add_f32 v4, v151 offset:1036
    ds_add_f32 v4, v152 offset:2048
    ds_add_f32 v4, v153 offset:2052
    ds_add_f32 v4, v154 offset:2056
    ds_add_f32 v4, v155 offset:2060
    s_waitcnt lgkmcnt(0)
    v_mov_b32 v144, 0
    v_mov_b32 v145, 0
    v_mov_b32 v146, 0
    v_mov_b32 v147, 0
    v_mov_b32 v148, 0
    v_mov_b32 v149, 0
    v_mov_b32 v150, 0
    v_mov_b32 v151, 0
    v_mov_b32 v152, 0
    v_mov_b32 v153, 0
    v_mov_b32 v154, 0
    v_mov_b32 v155, 0
    v_mov_b32 v156, 0
    v_mov_b32 v157, 0
    v_mov_b32 v158, 0
    v_mov_b32 v159, 0
    v_add_u32 v2, 8192, v2
    v_add_u32 v4, 8192, v4
    v_add_u32 v3, 128, v3
    s_add_u32 s42, s42, 1
    s_cmp_lt_u32 s42, 8
    s_cbranch_scc1 L_fb1
    s_lshl_b32 s38, s36, 2
    s_add_u32 s38, s38, 162064
    v_mov_b32 v6, s38
    v_mov_b32 v7, s37
    s_waitcnt lgkmcnt(0)
    ds_write_b32 v6, v7
    v_bfe_u32 v6, v1, 4, 3
    v_lshlrev_b32 v6, 2, v6
    v_add_u32 v6, 162064, v6
    s_mov_b32 s43, 0
L_ga_21:
    ds_read_b32 v7, v6
    s_add_u32 s43, s43, 1
    s_waitcnt lgkmcnt(0)
    v_subrev_u32 v7, s37, v7
    v_cmp_lt_u32 vcc, 1, v7
    s_cmp_eq_u64 vcc, 0
    s_cbranch_scc1 L_gad_22
    s_sleep 4
    s_cmp_lt_u32 s43, 1048576
    s_cbranch_scc1 L_ga_21
L_gad_22:
    s_cmp_eq_u32 s8, 0
    s_cbranch_scc1 L_att_end
    s_lshl_b32 s38, s9, 13
    v_add_u32 v4, s38, v1
    s_mov_b32 s54, 1
    s_mov_b32 s43, 1048576
    s_branch L_att_fin
L_fl_skip:
    v_mov_b32 v116, 0
    v_mov_b32 v117, 0
    v_mov_b32 v118, 0
    s_branch L_fl_done
L_gemmw:
    s_lshl4_add_u32 s40, s2, s36
    s_cmp_lg_u32 s40, 8
    s_waitcnt lgkmcnt(0)
    s_cbranch_scc1 L_notag
    s_or_b32 s47, s46, 1
    s_bitset0_b32 s47, 30
    v_mov_b32 v4, s47
    s_mov_b64 exec, 1
    global_store_dword v0, v4, s[18:19] sc1
    s_mov_b64 exec, -1
L_notag:
    s_mov_b32 s24, s20
    s_mov_b32 s25, s21
    s_mov_b32 s26, 0x16f0000
    s_mov_b32 s27, 0x20000
    s_setprio 3
    s_sub_u32 s46, s36, 8
    v_and_b32 v3, 1, v0
    v_bfe_u32 v4, v0, 1, 1
    v_lshl_or_b32 v3, v3, 1, v4
    v_lshlrev_b32 v3, 3, v3
    v_bfe_u32 v4, v0, 4, 1
    v_lshl_add_u32 v3, v4, 5, v3
    v_bfe_u32 v4, v0, 2, 2
    v_lshrrev_b32 v6, 5, v0
    v_lshl_add_u32 v4, v6, 3, v4
    v_mul_u32_u24 v4, 192, v4
    v_add_u32 v6, v3, v4
    v_and_b32 v3, 1, v0
    v_bfe_u32 v4, v0, 1, 1
    v_lshl_or_b32 v3, v3, 1, v4
    v_lshlrev_b32 v3, 3, v3
    v_bfe_u32 v4, v0, 4, 1
    v_lshl_add_u32 v3, v4, 5, v3
    v_bfe_u32 v4, v0, 2, 2
    v_lshrrev_b32 v2, 5, v0
    v_lshl_add_u32 v4, v2, 3, v4
    v_mul_u32_u24 v4, 256, v4
    v_add_u32 v2, v3, v4
    v_bfe_u32 v7, v0, 2, 2
    v_lshl_add_u32 v2, v7, 6, v2
    v_add_u32 v2, 49152, v2
    v_add_u32 v6, 49152, v6
    v_and_b32 v7, 31, v0
    v_and_b32 v3, 0x13, v7
    v_and_b32 v4, 4, v7
    v_lshl_or_b32 v3, v4, 1, v3
    v_and_b32 v4, 8, v7
    v_lshrrev_b32 v4, 1, v4
    v_or_b32 v136, v3, v4
    v_lshlrev_b32 v137, 2, v136
    v_add_u32 v137, 106496, v137
    v_lshrrev_b32 v3, 5, v0
    v_lshlrev_b32 v136, 4, v136
    v_lshl_add_u32 v136, v3, 9, v136
    v_bfe_u32 v4, v0, 1, 3
    v_xor_b32 v3, v3, v4
    v_lshlrev_b32 v3, 4, v3
    v_lshl_add_u32 v3, v7, 7, v3
    s_lshl_b32 s38, s46, 12
    v_add_u32 v1, s38, v3
    v_xor_b32 v3, 64, v2
    v_xor_b32 v4, 128, v2
    v_xor_b32 v5, 192, v2
    v_mov_b32 v8, 0
    v_mov_b32 v9, 0
    v_mov_b32 v10, 0
    v_mov_b32 v11, 0
    v_mov_b32 v12, 0
    v_mov_b32 v13, 0
    v_mov_b32 v14, 0
    v_mov_b32 v15, 0
    v_mov_b32 v16, 0
    v_mov_b32 v17, 0
    v_mov_b32 v18, 0
    v_mov_b32 v19, 0
    v_mov_b32 v20, 0
    v_mov_b32 v21, 0
    v_mov_b32 v22, 0
    v_mov_b32 v23, 0
    v_mov_b32 v24, 0
    v_mov_b32 v25, 0
    v_mov_b32 v26, 0
    v_mov_b32 v27, 0
    v_mov_b32 v28, 0
    v_mov_b32 v29, 0
    v_mov_b32 v30, 0
    v_mov_b32 v31, 0
    v_mov_b32 v32, 0
    v_mov_b32 v33, 0
    v_mov_b32 v34, 0
    v_mov_b32 v35, 0
    v_mov_b32 v36, 0
    v_mov_b32 v37, 0
    v_mov_b32 v38, 0
    v_mov_b32 v39, 0
    v_mov_b32 v40, 0
    v_mov_b32 v41, 0
    v_mov_b32 v42, 0
    v_mov_b32 v43, 0
    v_mov_b32 v44, 0
    v_mov_b32 v45, 0
    v_mov_b32 v46, 0
    v_mov_b32 v47, 0
    v_mov_b32 v48, 0
    v_mov_b32 v49, 0
    v_mov_b32 v50, 0
    v_mov_b32 v51, 0
    v_mov_b32 v52, 0
    v_mov_b32 v53, 0
    v_mov_b32 v54, 0
    v_mov_b32 v55, 0
    v_mov_b32 v56, 0
    v_mov_b32 v57, 0
    v_mov_b32 v58, 0
    v_mov_b32 v59, 0
    v_mov_b32 v60, 0
    v_mov_b32 v61, 0
    v_mov_b32 v62, 0
    v_mov_b32 v63, 0
    v_mov_b32 v64, 0
    v_mov_b32 v65, 0
    v_mov_b32 v66, 0
    v_mov_b32 v67, 0
    v_mov_b32 v68, 0
    v_mov_b32 v69, 0
    v_mov_b32 v70, 0
    v_mov_b32 v71, 0
    v_mov_b32 v72, 0
    v_mov_b32 v73, 0
    v_mov_b32 v74, 0
    v_mov_b32 v75, 0
    v_mov_b32 v76, 0
    v_mov_b32 v77, 0
    v_mov_b32 v78, 0
    v_mov_b32 v79, 0
    v_mov_b32 v80, 0
    v_mov_b32 v81, 0
    v_mov_b32 v82, 0
    v_mov_b32 v83, 0
    v_mov_b32 v84, 0
    v_mov_b32 v85, 0
    v_mov_b32 v86, 0
    v_mov_b32 v87, 0
    v_mov_b32 v88, 0
    v_mov_b32 v89, 0
    v_mov_b32 v90, 0
    v_mov_b32 v91, 0
    v_mov_b32 v92, 0
    v_mov_b32 v93, 0
    v_mov_b32 v94, 0
    v_mov_b32 v95, 0
    v_mov_b32 v96, 0
    v_mov_b32 v97, 0
    v_mov_b32 v98, 0
    v_mov_b32 v99, 0
    v_mov_b32 v100, 0
    v_mov_b32 v101, 0
    v_mov_b32 v102, 0
    v_mov_b32 v103, 0
    v_mov_b32 v104, 0
    v_mov_b32 v105, 0
    v_mov_b32 v106, 0
    v_mov_b32 v107, 0
    v_mov_b32 v108, 0
    v_mov_b32 v109, 0
    v_mov_b32 v110, 0
    v_mov_b32 v111, 0
    v_mov_b32 v112, 0
    v_mov_b32 v113, 0
    v_mov_b32 v114, 0
    v_mov_b32 v115, 0
    v_mov_b32 v116, 0
    v_mov_b32 v117, 0
    v_mov_b32 v118, 0
    v_mov_b32 v119, 0
    s_min_u32 s39, s45, 14
    s_mul_i32 s51, s39, 52
    s_lshr_b32 s51, s51, 8
    s_lshl2_add_u32 s38, s44, s46
    s_mul_i32 s50, s38, 40960
    s_lshl4_add_u32 s52, s38, s45
    s_lshl_b32 s52, s52, 7
    s_add_u32 s52, s52, 0x1610000
    s_mul_i32 s40, s51, 5
    s_sub_u32 s39, s39, s40
    s_mul_i32 s40, s51, 0x280000
    s_add_u32 s50, s50, s40
    s_cmp_eq_u32 s51, 2
    s_cselect_b32 s40, 11, 13
    s_lshl_b32 s39, s39, s40
    s_add_u32 s50, s50, s39
    s_cmp_eq_u32 s45, 15
    s_cselect_b32 s50, 0x4000000, s50
    s_lshl_b32 s41, s46, 7
    s_mov_b32 s53, 0
    s_movk_i32 s56, 0x380
    s_movk_i32 s48, 0x248
    s_barrier
    ds_read_b128 v[120:123], v1 offset:0
    ds_read_b64_tr_b16 v[140:141], v2 offset:0
    ds_read_b64_tr_b16 v[142:143], v2 offset:1024
    v_xor_b32 v7, 32, v1
    ds_read_b128 v[124:127], v7 offset:0
    ds_read_b64_tr_b16 v[144:145], v3 offset:0
    ds_read_b64_tr_b16 v[146:147], v3 offset:1024
    v_xor_b32 v7, 64, v1
    ds_read_b128 v[128:131], v7 offset:0
    ds_read_b64_tr_b16 v[148:149], v4 offset:0
    ds_read_b64_tr_b16 v[150:151], v4 offset:1024
    ds_read_b64_tr_b16 v[152:153], v5 offset:0
    ds_read_b64_tr_b16 v[154:155], v5 offset:1024
    ds_read_b64_tr_b16 v[156:157], v6 offset:16384
    ds_read_b64_tr_b16 v[158:159], v6 offset:17152
    ds_read_b64_tr_b16 v[160:161], v6 offset:16448
    ds_read_b64_tr_b16 v[162:163], v6 offset:17216
    ds_read_b64_tr_b16 v[164:165], v6 offset:16512
    ds_read_b64_tr_b16 v[166:167], v6 offset:17280
    s_cmp_eq_u32 s51, 2
    s_cbranch_scc1 L_p1_v
    s_branch L_gm_n
.p2align 6
L_g_n:
    s_waitcnt lgkmcnt(6)
    v_mfma_f32_32x32x16_bf16 v[8:23], v[140:143], v[132:135], v[8:23]
    s_barrier
    ds_read_b128 v[120:123], v1 offset:0
    ds_read_b64_tr_b16 v[140:141], v2 offset:0
    ds_read_b64_tr_b16 v[142:143], v2 offset:1024
    s_waitcnt lgkmcnt(6)
    v_mfma_f32_32x32x16_bf16 v[24:39], v[144:147], v[132:135], v[24:39]
    v_xor_b32 v7, 32, v1
    ds_read_b128 v[124:127], v7 offset:0
    ds_read_b64_tr_b16 v[144:145], v3 offset:0
    ds_read_b64_tr_b16 v[146:147], v3 offset:1024
    s_waitcnt lgkmcnt(6)
    v_mfma_f32_32x32x16_bf16 v[40:55], v[148:151], v[132:135], v[40:55]
    v_xor_b32 v7, 64, v1
    ds_read_b128 v[128:131], v7 offset:0
    ds_read_b64_tr_b16 v[148:149], v4 offset:0
    ds_read_b64_tr_b16 v[150:151], v4 offset:1024
    s_waitcnt lgkmcnt(6)
    v_mfma_f32_32x32x16_bf16 v[56:71], v[152:155], v[132:135], v[56:71]
    ds_read_b64_tr_b16 v[152:153], v5 offset:0
    ds_read_b64_tr_b16 v[154:155], v5 offset:1024
    s_cbranch_vccnz L_gs3_n
    v_mfma_f32_32x32x16_bf16 v[72:87], v[156:159], v[132:135], v[72:87]
    v_add_u32 v6, s38, v6
    ds_read_b64_tr_b16 v[156:157], v6 offset:16384
    ds_read_b64_tr_b16 v[158:159], v6 offset:17152
    v_mfma_f32_32x32x16_bf16 v[88:103], v[160:163], v[132:135], v[88:103]
    ds_read_b64_tr_b16 v[160:161], v6 offset:16448
    ds_read_b64_tr_b16 v[162:163], v6 offset:17216
    v_mfma_f32_32x32x16_bf16 v[104:119], v[164:167], v[132:135], v[104:119]
    ds_read_b64_tr_b16 v[164:165], v6 offset:16512
    ds_read_b64_tr_b16 v[166:167], v6 offset:17280
L_gs3_n:
L_gm_n:
    s_waitcnt lgkmcnt(6)
    v_mfma_f32_32x32x16_bf16 v[8:23], v[140:143], v[120:123], v[8:23]
    v_xor_b32 v7, 96, v1
    ds_read_b128 v[132:135], v7 offset:0
    ds_read_b64_tr_b16 v[140:141], v2 offset:4096
    ds_read_b64_tr_b16 v[142:143], v2 offset:5120
    s_waitcnt lgkmcnt(6)
    v_mfma_f32_32x32x16_bf16 v[24:39], v[144:147], v[120:123], v[24:39]
    ds_read_b64_tr_b16 v[144:145], v3 offset:4096
    ds_read_b64_tr_b16 v[146:147], v3 offset:5120
    s_bitcmp1_b32 s56, s53
    s_cselect_b64 vcc, -1, 0
    s_waitcnt lgkmcnt(6)
    v_mfma_f32_32x32x16_bf16 v[40:55], v[148:151], v[120:123], v[40:55]
    ds_read_b64_tr_b16 v[148:149], v4 offset:4096
    ds_read_b64_tr_b16 v[150:151], v4 offset:5120
    s_add_u32 s53, s53, 1
    s_bitcmp1_b32 s48, s53
    s_cselect_b32 s47, -2, 1
    s_waitcnt lgkmcnt(6)
    v_mfma_f32_32x32x16_bf16 v[56:71], v[152:155], v[120:123], v[56:71]
    ds_read_b64_tr_b16 v[152:153], v5 offset:4096
    ds_read_b64_tr_b16 v[154:155], v5 offset:5120
    s_cbranch_vccnz L_gs0_n
    v_mfma_f32_32x32x16_bf16 v[72:87], v[156:159], v[120:123], v[72:87]
    ds_read_b64_tr_b16 v[156:157], v6 offset:19456
    ds_read_b64_tr_b16 v[158:159], v6 offset:20224
    v_mfma_f32_32x32x16_bf16 v[88:103], v[160:163], v[120:123], v[88:103]
    ds_read_b64_tr_b16 v[160:161], v6 offset:19520
    ds_read_b64_tr_b16 v[162:163], v6 offset:20288
    v_mfma_f32_32x32x16_bf16 v[104:119], v[164:167], v[120:123], v[104:119]
    ds_read_b64_tr_b16 v[164:165], v6 offset:19584
    ds_read_b64_tr_b16 v[166:167], v6 offset:20352
L_gs0_n:
    s_waitcnt lgkmcnt(6)
    v_mfma_f32_32x32x16_bf16 v[8:23], v[140:143], v[124:127], v[8:23]
    ds_read_b64_tr_b16 v[140:141], v2 offset:8192
    ds_read_b64_tr_b16 v[142:143], v2 offset:9216
    s_lshl_b32 s47, s47, 14
    v_add_u32 v1, s47, v1
    s_waitcnt lgkmcnt(6)
    v_mfma_f32_32x32x16_bf16 v[24:39], v[144:147], v[124:127], v[24:39]
    ds_read_b64_tr_b16 v[144:145], v3 offset:8192
    ds_read_b64_tr_b16 v[146:147], v3 offset:9216
    s_and_b32 s38, s53, 3
    s_cselect_b32 s38, 1, -3
    s_waitcnt lgkmcnt(6)
    v_mfma_f32_32x32x16_bf16 v[40:55], v[148:151], v[124:127], v[40:55]
    ds_read_b64_tr_b16 v[148:149], v4 offset:8192
    ds_read_b64_tr_b16 v[150:151], v4 offset:9216
    s_mul_i32 s38, s38, 28672
    s_cmp_lt_u32 s53, 10
    s_waitcnt lgkmcnt(6)
    v_mfma_f32_32x32x16_bf16 v[56:71], v[152:155], v[124:127], v[56:71]
    ds_read_b64_tr_b16 v[152:153], v5 offset:8192
    ds_read_b64_tr_b16 v[154:155], v5 offset:9216
    s_cbranch_vccnz L_gs1_n
    v_mfma_f32_32x32x16_bf16 v[72:87], v[156:159], v[124:127], v[72:87]
    ds_read_b64_tr_b16 v[156:157], v6 offset:22528
    ds_read_b64_tr_b16 v[158:159], v6 offset:23296
    v_mfma_f32_32x32x16_bf16 v[88:103], v[160:163], v[124:127], v[88:103]
    ds_read_b64_tr_b16 v[160:161], v6 offset:22592
    ds_read_b64_tr_b16 v[162:163], v6 offset:23360
    v_mfma_f32_32x32x16_bf16 v[104:119], v[164:167], v[124:127], v[104:119]
    ds_read_b64_tr_b16 v[164:165], v6 offset:22656
    ds_read_b64_tr_b16 v[166:167], v6 offset:23424
L_gs1_n:
    s_waitcnt lgkmcnt(6)
    v_mfma_f32_32x32x16_bf16 v[8:23], v[140:143], v[128:131], v[8:23]
    ds_read_b64_tr_b16 v[140:141], v2 offset:12288
    ds_read_b64_tr_b16 v[142:143], v2 offset:13312
    v_add_u32 v2, s38, v2
    s_waitcnt lgkmcnt(6)
    v_mfma_f32_32x32x16_bf16 v[24:39], v[144:147], v[128:131], v[24:39]
    ds_read_b64_tr_b16 v[144:145], v3 offset:12288
    ds_read_b64_tr_b16 v[146:147], v3 offset:13312
    v_add_u32 v3, s38, v3
    s_waitcnt lgkmcnt(6)
    v_mfma_f32_32x32x16_bf16 v[40:55], v[148:151], v[128:131], v[40:55]
    ds_read_b64_tr_b16 v[148:149], v4 offset:12288
    ds_read_b64_tr_b16 v[150:151], v4 offset:13312
    v_add_u32 v4, s38, v4
    s_waitcnt lgkmcnt(6)
    v_mfma_f32_32x32x16_bf16 v[56:71], v[152:155], v[128:131], v[56:71]
    ds_read_b64_tr_b16 v[152:153], v5 offset:12288
    ds_read_b64_tr_b16 v[154:155], v5 offset:13312
    v_add_u32 v5, s38, v5
    s_cbranch_vccnz L_gs2_n
    v_mfma_f32_32x32x16_bf16 v[72:87], v[156:159], v[128:131], v[72:87]
    ds_read_b64_tr_b16 v[156:157], v6 offset:25600
    ds_read_b64_tr_b16 v[158:159], v6 offset:26368
    v_mfma_f32_32x32x16_bf16 v[88:103], v[160:163], v[128:131], v[88:103]
    ds_read_b64_tr_b16 v[160:161], v6 offset:25664
    ds_read_b64_tr_b16 v[162:163], v6 offset:26432
    v_mfma_f32_32x32x16_bf16 v[104:119], v[164:167], v[128:131], v[104:119]
    ds_read_b64_tr_b16 v[164:165], v6 offset:25728
    ds_read_b64_tr_b16 v[166:167], v6 offset:26496
L_gs2_n:
    s_cbranch_scc1 L_g_n
    s_waitcnt lgkmcnt(6)
    v_mfma_f32_32x32x16_bf16 v[8:23], v[140:143], v[132:135], v[8:23]
    ds_read2_b32 v[120:121], v137 offset0:0 offset1:32
    ds_read2_b32 v[122:123], v137 offset0:64 offset1:96
    ds_read2_b32 v[124:125], v137 offset0:128 offset1:160
    ds_read2_b32 v[126:127], v137 offset0:192 offset1:192
    v_add_u32 v7, s41, v137
    ds_read_b32 v128, v7 offset:1024
    ds_read_b32 v138, v7 offset:1536
    v_mov_b32 v129, 0
    v_mov_b32 v130, 0
    s_waitcnt lgkmcnt(10)
    v_mfma_f32_32x32x16_bf16 v[24:39], v[144:147], v[132:135], v[24:39]
    s_waitcnt lgkmcnt(8)
    v_mfma_f32_32x32x16_bf16 v[40:55], v[148:151], v[132:135], v[40:55]
    s_waitcnt lgkmcnt(6)
    v_mfma_f32_32x32x16_bf16 v[56:71], v[152:155], v[132:135], v[56:71]
    s_waitcnt lgkmcnt(0)
    s_mov_b32 exec_lo, 0
    v_mov_b32 v128, 0
    s_mov_b64 exec, -1
    v_mov_b32 v131, v128
    v_mov_b32 v139, v138
    s_nop 0
    v_mfma_f32_32x32x8_bf16 v[8:23], v[120:121], v[128:129], v[8:23]
    v_mfma_f32_32x32x8_bf16 v[24:39], v[120:121], v[130:131], v[24:39]
    v_mfma_f32_32x32x8_bf16 v[40:55], v[122:123], v[128:129], v[40:55]
    v_mfma_f32_32x32x8_bf16 v[56:71], v[122:123], v[130:131], v[56:71]
    s_cmp_eq_u32 s51, 0
    s_cselect_b32 s39, 0x3ea52b5c, 1.0
    v_mul_f32 v2, s39, v138
    v_mul_f32 v3, s39, v138
    s_add_u32 s38, s50, 4096
    s_nop 3
    v_pk_mul_f32 v[8:9], v[8:9], v[2:3]
    v_pk_mul_f32 v[10:11], v[10:11], v[2:3]
    v_pk_mul_f32 v[12:13], v[12:13], v[2:3]
    v_pk_mul_f32 v[14:15], v[14:15], v[2:3]
    v_cvt_pk_bf16_f32 v8, v8, v9
    v_cvt_pk_bf16_f32 v9, v10, v11
    v_cvt_pk_bf16_f32 v10, v12, v13
    v_cvt_pk_bf16_f32 v11, v14, v15
    buffer_store_dwordx4 v[8:11], v136, s[24:27], s50 offen offset:0 sc1
    v_pk_mul_f32 v[16:17], v[16:17], v[2:3]
    v_pk_mul_f32 v[18:19], v[18:19], v[2:3]
    v_pk_mul_f32 v[20:21], v[20:21], v[2:3]
    v_pk_mul_f32 v[22:23], v[22:23], v[2:3]
    v_cvt_pk_bf16_f32 v16, v16, v17
    v_cvt_pk_bf16_f32 v17, v18, v19
    v_cvt_pk_bf16_f32 v18, v20, v21
    v_cvt_pk_bf16_f32 v19, v22, v23
    buffer_store_dwordx4 v[16:19], v136, s[24:27], s50 offen offset:1024 sc1
    v_pk_mul_f32 v[24:25], v[24:25], v[2:3]
    v_pk_mul_f32 v[26:27], v[26:27], v[2:3]
    v_pk_mul_f32 v[28:29], v[28:29], v[2:3]
    v_pk_mul_f32 v[30:31], v[30:31], v[2:3]
    v_cvt_pk_bf16_f32 v24, v24, v25
    v_cvt_pk_bf16_f32 v25, v26, v27
    v_cvt_pk_bf16_f32 v26, v28, v29
    v_cvt_pk_bf16_f32 v27, v30, v31
    buffer_store_dwordx4 v[24:27], v136, s[24:27], s50 offen offset:2048 sc1
    v_pk_mul_f32 v[32:33], v[32:33], v[2:3]
    v_pk_mul_f32 v[34:35], v[34:35], v[2:3]
    v_pk_mul_f32 v[36:37], v[36:37], v[2:3]
    v_pk_mul_f32 v[38:39], v[38:39], v[2:3]
    v_cvt_pk_bf16_f32 v32, v32, v33
    v_cvt_pk_bf16_f32 v33, v34, v35
    v_cvt_pk_bf16_f32 v34, v36, v37
    v_cvt_pk_bf16_f32 v35, v38, v39
    buffer_store_dwordx4 v[32:35], v136, s[24:27], s50 offen offset:3072 sc1
    v_pk_mul_f32 v[40:41], v[40:41], v[2:3]
    v_pk_mul_f32 v[42:43], v[42:43], v[2:3]
    v_pk_mul_f32 v[44:45], v[44:45], v[2:3]
    v_pk_mul_f32 v[46:47], v[46:47], v[2:3]
    v_cvt_pk_bf16_f32 v40, v40, v41
    v_cvt_pk_bf16_f32 v41, v42, v43
    v_cvt_pk_bf16_f32 v42, v44, v45
    v_cvt_pk_bf16_f32 v43, v46, v47
    buffer_store_dwordx4 v[40:43], v136, s[24:27], s38 offen offset:0 sc1
    v_pk_mul_f32 v[48:49], v[48:49], v[2:3]
    v_pk_mul_f32 v[50:51], v[50:51], v[2:3]
    v_pk_mul_f32 v[52:53], v[52:53], v[2:3]
    v_pk_mul_f32 v[54:55], v[54:55], v[2:3]
    v_cvt_pk_bf16_f32 v48, v48, v49
    v_cvt_pk_bf16_f32 v49, v50, v51
    v_cvt_pk_bf16_f32 v50, v52, v53
    v_cvt_pk_bf16_f32 v51, v54, v55
    buffer_store_dwordx4 v[48:51], v136, s[24:27], s38 offen offset:1024 sc1
    v_pk_mul_f32 v[56:57], v[56:57], v[2:3]
    v_pk_mul_f32 v[58:59], v[58:59], v[2:3]
    v_pk_mul_f32 v[60:61], v[60:61], v[2:3]
    v_pk_mul_f32 v[62:63], v[62:63], v[2:3]
    v_cvt_pk_bf16_f32 v56, v56, v57
    v_cvt_pk_bf16_f32 v57, v58, v59
    v_cvt_pk_bf16_f32 v58, v60, v61
    v_cvt_pk_bf16_f32 v59, v62, v63
    buffer_store_dwordx4 v[56:59], v136, s[24:27], s38 offen offset:2048 sc1
    v_pk_mul_f32 v[64:65], v[64:65], v[2:3]
    v_pk_mul_f32 v[66:67], v[66:67], v[2:3]
    v_pk_mul_f32 v[68:69], v[68:69], v[2:3]
    v_pk_mul_f32 v[70:71], v[70:71], v[2:3]
    v_cvt_pk_bf16_f32 v64, v64, v65
    v_cvt_pk_bf16_f32 v65, v66, v67
    v_cvt_pk_bf16_f32 v66, v68, v69
    v_cvt_pk_bf16_f32 v67, v70, v71
    buffer_store_dwordx4 v[64:67], v136, s[24:27], s38 offen offset:3072 sc1
    s_branch L_mlp1
L_p1_v:
    s_branch L_gm_v
.p2align 6
L_g_v:
    s_waitcnt lgkmcnt(6)
    v_mfma_f32_32x32x16_bf16 v[8:23], v[132:135], v[140:143], v[8:23]
    s_barrier
    ds_read_b128 v[120:123], v1 offset:0
    ds_read_b64_tr_b16 v[140:141], v2 offset:0
    ds_read_b64_tr_b16 v[142:143], v2 offset:1024
    s_waitcnt lgkmcnt(6)
    v_mfma_f32_32x32x16_bf16 v[24:39], v[132:135], v[144:147], v[24:39]
    v_xor_b32 v7, 32, v1
    ds_read_b128 v[124:127], v7 offset:0
    ds_read_b64_tr_b16 v[144:145], v3 offset:0
    ds_read_b64_tr_b16 v[146:147], v3 offset:1024
    s_waitcnt lgkmcnt(6)
    v_mfma_f32_32x32x16_bf16 v[40:55], v[132:135], v[148:151], v[40:55]
    v_xor_b32 v7, 64, v1
    ds_read_b128 v[128:131], v7 offset:0
    ds_read_b64_tr_b16 v[148:149], v4 offset:0
    ds_read_b64_tr_b16 v[150:151], v4 offset:1024
    s_waitcnt lgkmcnt(6)
    v_mfma_f32_32x32x16_bf16 v[56:71], v[132:135], v[152:155], v[56:71]
    ds_read_b64_tr_b16 v[152:153], v5 offset:0
    ds_read_b64_tr_b16 v[154:155], v5 offset:1024
    s_cbranch_vccnz L_gs3_v
    v_mfma_f32_32x32x16_bf16 v[72:87], v[156:159], v[132:135], v[72:87]
    v_add_u32 v6, s38, v6
    ds_read_b64_tr_b16 v[156:157], v6 offset:16384
    ds_read_b64_tr_b16 v[158:159], v6 offset:17152
    v_mfma_f32_32x32x16_bf16 v[88:103], v[160:163], v[132:135], v[88:103]
    ds_read_b64_tr_b16 v[160:161], v6 offset:16448
    ds_read_b64_tr_b16 v[162:163], v6 offset:17216
    v_mfma_f32_32x32x16_bf16 v[104:119], v[164:167], v[132:135], v[104:119]
    ds_read_b64_tr_b16 v[164:165], v6 offset:16512
    ds_read_b64_tr_b16 v[166:167], v6 offset:17280
L_gs3_v:
L_gm_v:
    s_waitcnt lgkmcnt(6)
    v_mfma_f32_32x32x16_bf16 v[8:23], v[120:123], v[140:143], v[8:23]
    v_xor_b32 v7, 96, v1
    ds_read_b128 v[132:135], v7 offset:0
    ds_read_b64_tr_b16 v[140:141], v2 offset:4096
    ds_read_b64_tr_b16 v[142:143], v2 offset:5120
    s_waitcnt lgkmcnt(6)
    v_mfma_f32_32x32x16_bf16 v[24:39], v[120:123], v[144:147], v[24:39]
    ds_read_b64_tr_b16 v[144:145], v3 offset:4096
    ds_read_b64_tr_b16 v[146:147], v3 offset:5120
    s_bitcmp1_b32 s56, s53
    s_cselect_b64 vcc, -1, 0
    s_waitcnt lgkmcnt(6)
    v_mfma_f32_32x32x16_bf16 v[40:55], v[120:123], v[148:151], v[40:55]
    ds_read_b64_tr_b16 v[148:149], v4 offset:4096
    ds_read_b64_tr_b16 v[150:151], v4 offset:5120
    s_add_u32 s53, s53, 1
    s_bitcmp1_b32 s48, s53
    s_cselect_b32 s47, -2, 1
    s_waitcnt lgkmcnt(6)
    v_mfma_f32_32x32x16_bf16 v[56:71], v[120:123], v[152:155], v[56:71]
    ds_read_b64_tr_b16 v[152:153], v5 offset:4096
    ds_read_b64_tr_b16 v[154:155], v5 offset:5120
    s_cbranch_vccnz L_gs0_v
    v_mfma_f32_32x32x16_bf16 v[72:87], v[156:159], v[120:123], v[72:87]
    ds_read_b64_tr_b16 v[156:157], v6 offset:19456
    ds_read_b64_tr_b16 v[158:159], v6 offset:20224
    v_mfma_f32_32x32x16_bf16 v[88:103], v[160:163], v[120:123], v[88:103]
    ds_read_b64_tr_b16 v[160:161], v6 offset:19520
    ds_read_b64_tr_b16 v[162:163], v6 offset:20288
    v_mfma_f32_32x32x16_bf16 v[104:119], v[164:167], v[120:123], v[104:119]
    ds_read_b64_tr_b16 v[164:165], v6 offset:19584
    ds_read_b64_tr_b16 v[166:167], v6 offset:20352
L_gs0_v:
    s_waitcnt lgkmcnt(6)
    v_mfma_f32_32x32x16_bf16 v[8:23], v[124:127], v[140:143], v[8:23]
    ds_read_b64_tr_b16 v[140:141], v2 offset:8192
    ds_read_b64_tr_b16 v[142:143], v2 offset:9216
    s_lshl_b32 s47, s47, 14
    v_add_u32 v1, s47, v1
    s_waitcnt lgkmcnt(6)
    v_mfma_f32_32x32x16_bf16 v[24:39], v[124:127], v[144:147], v[24:39]
    ds_read_b64_tr_b16 v[144:145], v3 offset:8192
    ds_read_b64_tr_b16 v[146:147], v3 offset:9216
    s_and_b32 s38, s53, 3
    s_cselect_b32 s38, 1, -3
    s_waitcnt lgkmcnt(6)
    v_mfma_f32_32x32x16_bf16 v[40:55], v[124:127], v[148:151], v[40:55]
    ds_read_b64_tr_b16 v[148:149], v4 offset:8192
    ds_read_b64_tr_b16 v[150:151], v4 offset:9216
    s_mul_i32 s38, s38, 28672
    s_cmp_lt_u32 s53, 10
    s_waitcnt lgkmcnt(6)
    v_mfma_f32_32x32x16_bf16 v[56:71], v[124:127], v[152:155], v[56:71]
    ds_read_b64_tr_b16 v[152:153], v5 offset:8192
    ds_read_b64_tr_b16 v[154:155], v5 offset:9216
    s_cbranch_vccnz L_gs1_v
    v_mfma_f32_32x32x16_bf16 v[72:87], v[156:159], v[124:127], v[72:87]
    ds_read_b64_tr_b16 v[156:157], v6 offset:22528
    ds_read_b64_tr_b16 v[158:159], v6 offset:23296
    v_mfma_f32_32x32x16_bf16 v[88:103], v[160:163], v[124:127], v[88:103]
    ds_read_b64_tr_b16 v[160:161], v6 offset:22592
    ds_read_b64_tr_b16 v[162:163], v6 offset:23360
    v_mfma_f32_32x32x16_bf16 v[104:119], v[164:167], v[124:127], v[104:119]
    ds_read_b64_tr_b16 v[164:165], v6 offset:22656
    ds_read_b64_tr_b16 v[166:167], v6 offset:23424
L_gs1_v:
    s_waitcnt lgkmcnt(6)
    v_mfma_f32_32x32x16_bf16 v[8:23], v[128:131], v[140:143], v[8:23]
    ds_read_b64_tr_b16 v[140:141], v2 offset:12288
    ds_read_b64_tr_b16 v[142:143], v2 offset:13312
    v_add_u32 v2, s38, v2
    s_waitcnt lgkmcnt(6)
    v_mfma_f32_32x32x16_bf16 v[24:39], v[128:131], v[144:147], v[24:39]
    ds_read_b64_tr_b16 v[144:145], v3 offset:12288
    ds_read_b64_tr_b16 v[146:147], v3 offset:13312
    v_add_u32 v3, s38, v3
    s_waitcnt lgkmcnt(6)
    v_mfma_f32_32x32x16_bf16 v[40:55], v[128:131], v[148:151], v[40:55]
    ds_read_b64_tr_b16 v[148:149], v4 offset:12288
    ds_read_b64_tr_b16 v[150:151], v4 offset:13312
    v_add_u32 v4, s38, v4
    s_waitcnt lgkmcnt(6)
    v_mfma_f32_32x32x16_bf16 v[56:71], v[128:131], v[152:155], v[56:71]
    ds_read_b64_tr_b16 v[152:153], v5 offset:12288
    ds_read_b64_tr_b16 v[154:155], v5 offset:13312
    v_add_u32 v5, s38, v5
    s_cbranch_vccnz L_gs2_v
    v_mfma_f32_32x32x16_bf16 v[72:87], v[156:159], v[128:131], v[72:87]
    ds_read_b64_tr_b16 v[156:157], v6 offset:25600
    ds_read_b64_tr_b16 v[158:159], v6 offset:26368
    v_mfma_f32_32x32x16_bf16 v[88:103], v[160:163], v[128:131], v[88:103]
    ds_read_b64_tr_b16 v[160:161], v6 offset:25664
    ds_read_b64_tr_b16 v[162:163], v6 offset:26432
    v_mfma_f32_32x32x16_bf16 v[104:119], v[164:167], v[128:131], v[104:119]
    ds_read_b64_tr_b16 v[164:165], v6 offset:25728
    ds_read_b64_tr_b16 v[166:167], v6 offset:26496
L_gs2_v:
    s_cbranch_scc1 L_g_v
    s_waitcnt lgkmcnt(6)
    v_mfma_f32_32x32x16_bf16 v[8:23], v[132:135], v[140:143], v[8:23]
    ds_read2_b32 v[120:121], v137 offset0:0 offset1:32
    ds_read2_b32 v[122:123], v137 offset0:64 offset1:96
    ds_read2_b32 v[124:125], v137 offset0:128 offset1:160
    ds_read2_b32 v[126:127], v137 offset0:192 offset1:192
    v_add_u32 v7, s41, v137
    ds_read_b32 v128, v7 offset:1024
    ds_read_b32 v138, v7 offset:1536
    v_mov_b32 v129, 0
    v_mov_b32 v130, 0
    s_waitcnt lgkmcnt(10)
    v_mfma_f32_32x32x16_bf16 v[24:39], v[132:135], v[144:147], v[24:39]
    s_waitcnt lgkmcnt(8)
    v_mfma_f32_32x32x16_bf16 v[40:55], v[132:135], v[148:151], v[40:55]
    s_waitcnt lgkmcnt(6)
    v_mfma_f32_32x32x16_bf16 v[56:71], v[132:135], v[152:155], v[56:71]
    v_and_b32 v7, 32, v0
    s_add_u32 s39, s41, 108032
    v_add_u32 v7, s39, v7
    ds_read_b128 v[140:143], v7 offset:0
    ds_read_b128 v[144:147], v7 offset:16
    ds_read_b128 v[148:151], v7 offset:64
    ds_read_b128 v[152:155], v7 offset:80
    s_waitcnt lgkmcnt(4)
    s_mov_b32 exec_lo, 0
    v_mov_b32 v128, 0
    s_mov_b64 exec, -1
    v_mov_b32 v131, v128
    v_mov_b32 v139, v138
    s_nop 0
    v_mfma_f32_32x32x8_bf16 v[8:23], v[128:129], v[120:121], v[8:23]
    v_mfma_f32_32x32x8_bf16 v[24:39], v[130:131], v[120:121], v[24:39]
    v_mfma_f32_32x32x8_bf16 v[40:55], v[128:129], v[122:123], v[40:55]
    v_mfma_f32_32x32x8_bf16 v[56:71], v[130:131], v[122:123], v[56:71]
    v_lshrrev_b32 v7, 5, v0
    v_mul_u32_u24 v7, 9728, v7
    v_add_u32 v4, v7, v136
    s_add_u32 s38, s50, 20480
    s_waitcnt lgkmcnt(0)
    s_nop 3
    v_pk_mul_f32 v[8:9], v[8:9], v[140:141]
    v_pk_mul_f32 v[10:11], v[10:11], v[142:143]
    v_pk_mul_f32 v[12:13], v[12:13], v[144:145]
    v_pk_mul_f32 v[14:15], v[14:15], v[146:147]
    v_cvt_pk_bf16_f32 v8, v8, v9
    v_cvt_pk_bf16_f32 v9, v10, v11
    v_cvt_pk_bf16_f32 v10, v12, v13
    v_cvt_pk_bf16_f32 v11, v14, v15
    buffer_store_dwordx4 v[8:11], v4, s[24:27], s50 offen offset:0 sc1
    v_pk_mul_f32 v[16:17], v[16:17], v[148:149]
    v_pk_mul_f32 v[18:19], v[18:19], v[150:151]
    v_pk_mul_f32 v[20:21], v[20:21], v[152:153]
    v_pk_mul_f32 v[22:23], v[22:23], v[154:155]
    v_cvt_pk_bf16_f32 v16, v16, v17
    v_cvt_pk_bf16_f32 v17, v18, v19
    v_cvt_pk_bf16_f32 v18, v20, v21
    v_cvt_pk_bf16_f32 v19, v22, v23
    buffer_store_dwordx4 v[16:19], v4, s[24:27], s38 offen offset:0 sc1
    v_pk_mul_f32 v[24:25], v[24:25], v[140:141]
    v_pk_mul_f32 v[26:27], v[26:27], v[142:143]
    v_pk_mul_f32 v[28:29], v[28:29], v[144:145]
    v_pk_mul_f32 v[30:31], v[30:31], v[146:147]
    v_cvt_pk_bf16_f32 v24, v24, v25
    v_cvt_pk_bf16_f32 v25, v26, v27
    v_cvt_pk_bf16_f32 v26, v28, v29
    v_cvt_pk_bf16_f32 v27, v30, v31
    buffer_store_dwordx4 v[24:27], v4, s[24:27], s50 offen offset:512 sc1
    v_pk_mul_f32 v[32:33], v[32:33], v[148:149]
    v_pk_mul_f32 v[34:35], v[34:35], v[150:151]
    v_pk_mul_f32 v[36:37], v[36:37], v[152:153]
    v_pk_mul_f32 v[38:39], v[38:39], v[154:155]
    v_cvt_pk_bf16_f32 v32, v32, v33
    v_cvt_pk_bf16_f32 v33, v34, v35
    v_cvt_pk_bf16_f32 v34, v36, v37
    v_cvt_pk_bf16_f32 v35, v38, v39
    buffer_store_dwordx4 v[32:35], v4, s[24:27], s38 offen offset:512 sc1
    v_pk_mul_f32 v[40:41], v[40:41], v[140:141]
    v_pk_mul_f32 v[42:43], v[42:43], v[142:143]
    v_pk_mul_f32 v[44:45], v[44:45], v[144:145]
    v_pk_mul_f32 v[46:47], v[46:47], v[146:147]
    v_cvt_pk_bf16_f32 v40, v40, v41
    v_cvt_pk_bf16_f32 v41, v42, v43
    v_cvt_pk_bf16_f32 v42, v44, v45
    v_cvt_pk_bf16_f32 v43, v46, v47
    buffer_store_dwordx4 v[40:43], v4, s[24:27], s50 offen offset:1024 sc1
    v_pk_mul_f32 v[48:49], v[48:49], v[148:149]
    v_pk_mul_f32 v[50:51], v[50:51], v[150:151]
    v_pk_mul_f32 v[52:53], v[52:53], v[152:153]
    v_pk_mul_f32 v[54:55], v[54:55], v[154:155]
    v_cvt_pk_bf16_f32 v48, v48, v49
    v_cvt_pk_bf16_f32 v49, v50, v51
    v_cvt_pk_bf16_f32 v50, v52, v53
    v_cvt_pk_bf16_f32 v51, v54, v55
    buffer_store_dwordx4 v[48:51], v4, s[24:27], s38 offen offset:1024 sc1
    v_pk_mul_f32 v[56:57], v[56:57], v[140:141]
    v_pk_mul_f32 v[58:59], v[58:59], v[142:143]
    v_pk_mul_f32 v[60:61], v[60:61], v[144:145]
    v_pk_mul_f32 v[62:63], v[62:63], v[146:147]
    v_cvt_pk_bf16_f32 v56, v56, v57
    v_cvt_pk_bf16_f32 v57, v58, v59
    v_cvt_pk_bf16_f32 v58, v60, v61
    v_cvt_pk_bf16_f32 v59, v62, v63
    buffer_store_dwordx4 v[56:59], v4, s[24:27], s50 offen offset:1536 sc1
    v_pk_mul_f32 v[64:65], v[64:65], v[148:149]
    v_pk_mul_f32 v[66:67], v[66:67], v[150:151]
    v_pk_mul_f32 v[68:69], v[68:69], v[152:153]
    v_pk_mul_f32 v[70:71], v[70:71], v[154:155]
    v_cvt_pk_bf16_f32 v64, v64, v65
    v_cvt_pk_bf16_f32 v65, v66, v67
    v_cvt_pk_bf16_f32 v66, v68, v69
    v_cvt_pk_bf16_f32 v67, v70, v71
    buffer_store_dwordx4 v[64:67], v4, s[24:27], s38 offen offset:1536 sc1
L_mlp1:
    v_mov_b32 v2, 108544
    ds_read_b32 v2, v2
    v_mfma_f32_32x32x8_bf16 v[72:87], v[124:125], v[128:129], v[72:87]
    v_mfma_f32_32x32x8_bf16 v[88:103], v[124:125], v[130:131], v[88:103]
    v_mfma_f32_32x32x8_bf16 v[104:119], v[126:127], v[128:129], v[104:119]
    v_subrev_u32 v1, 16384, v1
    ds_read_b128 v[8:11], v1 offset:16384
    ds_read_b128 v[24:27], v1 offset:32768
    ds_read_b128 v[40:43], v1 offset:0
    v_xor_b32 v7, 32, v1
    ds_read_b128 v[12:15], v7 offset:16384
    ds_read_b128 v[28:31], v7 offset:32768
    ds_read_b128 v[44:47], v7 offset:0
    v_xor_b32 v7, 64, v1
    ds_read_b128 v[16:19], v7 offset:16384
    ds_read_b128 v[32:35], v7 offset:32768
    ds_read_b128 v[48:51], v7 offset:0
    v_xor_b32 v7, 96, v1
    ds_read_b128 v[20:23], v7 offset:16384
    ds_read_b128 v[36:39], v7 offset:32768
    ds_read_b128 v[52:55], v7 offset:0
    ds_read_b64_tr_b16 v[140:141], v6 offset:19456
    ds_read_b64_tr_b16 v[142:143], v6 offset:20224
    ds_read_b64_tr_b16 v[144:145], v6 offset:19520
    ds_read_b64_tr_b16 v[146:147], v6 offset:20288
    ds_read_b64_tr_b16 v[148:149], v6 offset:19584
    ds_read_b64_tr_b16 v[150:151], v6 offset:20352
    s_waitcnt lgkmcnt(6)
    v_mfma_f32_32x32x16_bf16 v[72:87], v[156:159], v[8:11], v[72:87]
    ds_read_b64_tr_b16 v[156:157], v6 offset:22528
    ds_read_b64_tr_b16 v[158:159], v6 offset:23296
    v_mfma_f32_32x32x16_bf16 v[88:103], v[160:163], v[8:11], v[88:103]
    ds_read_b64_tr_b16 v[160:161], v6 offset:22592
    ds_read_b64_tr_b16 v[162:163], v6 offset:23360
    v_mfma_f32_32x32x16_bf16 v[104:119], v[164:167], v[8:11], v[104:119]
    ds_read_b64_tr_b16 v[164:165], v6 offset:22656
    ds_read_b64_tr_b16 v[166:167], v6 offset:23424
    s_waitcnt lgkmcnt(6)
    v_mfma_f32_32x32x16_bf16 v[72:87], v[140:143], v[12:15], v[72:87]
    ds_read_b64_tr_b16 v[140:141], v6 offset:25600
    ds_read_b64_tr_b16 v[142:143], v6 offset:26368
    v_mfma_f32_32x32x16_bf16 v[88:103], v[144:147], v[12:15], v[88:103]
    ds_read_b64_tr_b16 v[144:145], v6 offset:25664
    ds_read_b64_tr_b16 v[146:147], v6 offset:26432
    v_mfma_f32_32x32x16_bf16 v[104:119], v[148:151], v[12:15], v[104:119]
    ds_read_b64_tr_b16 v[148:149], v6 offset:25728
    ds_read_b64_tr_b16 v[150:151], v6 offset:26496
    s_waitcnt lgkmcnt(6)
    v_subrev_u32 v6, 86016, v6
    v_mfma_f32_32x32x16_bf16 v[72:87], v[156:159], v[16:19], v[72:87]
    ds_read_b64_tr_b16 v[156:157], v6 offset:16384
    ds_read_b64_tr_b16 v[158:159], v6 offset:17152
    v_mfma_f32_32x32x16_bf16 v[88:103], v[160:163], v[16:19], v[88:103]
    ds_read_b64_tr_b16 v[160:161], v6 offset:16448
    ds_read_b64_tr_b16 v[162:163], v6 offset:17216
    v_mfma_f32_32x32x16_bf16 v[104:119], v[164:167], v[16:19], v[104:119]
    ds_read_b64_tr_b16 v[164:165], v6 offset:16512
    ds_read_b64_tr_b16 v[166:167], v6 offset:17280
    s_waitcnt lgkmcnt(6)
    v_mfma_f32_32x32x16_bf16 v[72:87], v[140:143], v[20:23], v[72:87]
    ds_read_b64_tr_b16 v[140:141], v6 offset:19456
    ds_read_b64_tr_b16 v[142:143], v6 offset:20224
    v_mfma_f32_32x32x16_bf16 v[88:103], v[144:147], v[20:23], v[88:103]
    ds_read_b64_tr_b16 v[144:145], v6 offset:19520
    ds_read_b64_tr_b16 v[146:147], v6 offset:20288
    v_mfma_f32_32x32x16_bf16 v[104:119], v[148:151], v[20:23], v[104:119]
    ds_read_b64_tr_b16 v[148:149], v6 offset:19584
    ds_read_b64_tr_b16 v[150:151], v6 offset:20352
    v_readfirstlane_b32 s37, v2
    s_nop 0
    s_waitcnt vmcnt(0)
    v_mov_b32 v7, s37
    s_mov_b64 exec, 0x1
    buffer_store_dword v7, off, s[24:27], s52 sc1
    s_mov_b64 exec, -1
    s_barrier
    s_waitcnt lgkmcnt(6)
    v_mfma_f32_32x32x16_bf16 v[72:87], v[156:159], v[24:27], v[72:87]
    ds_read_b64_tr_b16 v[156:157], v6 offset:22528
    ds_read_b64_tr_b16 v[158:159], v6 offset:23296
    v_mfma_f32_32x32x16_bf16 v[88:103], v[160:163], v[24:27], v[88:103]
    ds_read_b64_tr_b16 v[160:161], v6 offset:22592
    ds_read_b64_tr_b16 v[162:163], v6 offset:23360
    v_mfma_f32_32x32x16_bf16 v[104:119], v[164:167], v[24:27], v[104:119]
    ds_read_b64_tr_b16 v[164:165], v6 offset:22656
    ds_read_b64_tr_b16 v[166:167], v6 offset:23424
    s_waitcnt lgkmcnt(6)
    v_mfma_f32_32x32x16_bf16 v[72:87], v[140:143], v[28:31], v[72:87]
    ds_read_b64_tr_b16 v[140:141], v6 offset:25600
    ds_read_b64_tr_b16 v[142:143], v6 offset:26368
    v_mfma_f32_32x32x16_bf16 v[88:103], v[144:147], v[28:31], v[88:103]
    ds_read_b64_tr_b16 v[144:145], v6 offset:25664
    ds_read_b64_tr_b16 v[146:147], v6 offset:26432
    v_mfma_f32_32x32x16_bf16 v[104:119], v[148:151], v[28:31], v[104:119]
    ds_read_b64_tr_b16 v[148:149], v6 offset:25728
    ds_read_b64_tr_b16 v[150:151], v6 offset:26496
    s_waitcnt lgkmcnt(6)
    v_add_u32 v6, 28672, v6
    v_mfma_f32_32x32x16_bf16 v[72:87], v[156:159], v[32:35], v[72:87]
    ds_read_b64_tr_b16 v[156:157], v6 offset:16384
    ds_read_b64_tr_b16 v[158:159], v6 offset:17152
    v_mfma_f32_32x32x16_bf16 v[88:103], v[160:163], v[32:35], v[88:103]
    ds_read_b64_tr_b16 v[160:161], v6 offset:16448
    ds_read_b64_tr_b16 v[162:163], v6 offset:17216
    v_mfma_f32_32x32x16_bf16 v[104:119], v[164:167], v[32:35], v[104:119]
    ds_read_b64_tr_b16 v[164:165], v6 offset:16512
    ds_read_b64_tr_b16 v[166:167], v6 offset:17280
    s_waitcnt lgkmcnt(6)
    v_mfma_f32_32x32x16_bf16 v[72:87], v[140:143], v[36:39], v[72:87]
    ds_read_b64_tr_b16 v[140:141], v6 offset:19456
    ds_read_b64_tr_b16 v[142:143], v6 offset:20224
    v_mfma_f32_32x32x16_bf16 v[88:103], v[144:147], v[36:39], v[88:103]
    ds_read_b64_tr_b16 v[144:145], v6 offset:19520
    ds_read_b64_tr_b16 v[146:147], v6 offset:20288
    v_mfma_f32_32x32x16_bf16 v[104:119], v[148:151], v[36:39], v[104:119]
    ds_read_b64_tr_b16 v[148:149], v6 offset:19584
    ds_read_b64_tr_b16 v[150:151], v6 offset:20352
    s_waitcnt lgkmcnt(6)
    v_mfma_f32_32x32x16_bf16 v[72:87], v[156:159], v[40:43], v[72:87]
    ds_read_b64_tr_b16 v[156:157], v6 offset:22528
    ds_read_b64_tr_b16 v[158:159], v6 offset:23296
    v_mfma_f32_32x32x16_bf16 v[88:103], v[160:163], v[40:43], v[88:103]
    ds_read_b64_tr_b16 v[160:161], v6 offset:22592
    ds_read_b64_tr_b16 v[162:163], v6 offset:23360
    v_mfma_f32_32x32x16_bf16 v[104:119], v[164:167], v[40:43], v[104:119]
    ds_read_b64_tr_b16 v[164:165], v6 offset:22656
    ds_read_b64_tr_b16 v[166:167], v6 offset:23424
    s_waitcnt lgkmcnt(6)
    v_mfma_f32_32x32x16_bf16 v[72:87], v[140:143], v[44:47], v[72:87]
    ds_read_b64_tr_b16 v[140:141], v6 offset:25600
    ds_read_b64_tr_b16 v[142:143], v6 offset:26368
    v_mfma_f32_32x32x16_bf16 v[88:103], v[144:147], v[44:47], v[88:103]
    ds_read_b64_tr_b16 v[144:145], v6 offset:25664
    ds_read_b64_tr_b16 v[146:147], v6 offset:26432
    v_mfma_f32_32x32x16_bf16 v[104:119], v[148:151], v[44:47], v[104:119]
    ds_read_b64_tr_b16 v[148:149], v6 offset:25728
    ds_read_b64_tr_b16 v[150:151], v6 offset:26496
    s_waitcnt lgkmcnt(6)
    v_mfma_f32_32x32x16_bf16 v[72:87], v[156:159], v[48:51], v[72:87]
    v_mfma_f32_32x32x16_bf16 v[88:103], v[160:163], v[48:51], v[88:103]
    v_mfma_f32_32x32x16_bf16 v[104:119], v[164:167], v[48:51], v[104:119]
    s_waitcnt lgkmcnt(0)
    v_mfma_f32_32x32x16_bf16 v[72:87], v[140:143], v[52:55], v[72:87]
    v_mfma_f32_32x32x16_bf16 v[88:103], v[144:147], v[52:55], v[88:103]
    v_mfma_f32_32x32x16_bf16 v[104:119], v[148:151], v[52:55], v[104:119]
    s_lshl_b32 s38, s44, 2
    s_add_u32 s38, s38, s46
    s_mul_i32 s38, s38, 98304
    s_mul_i32 s39, s45, 6144
    s_add_u32 s38, s38, s39
    s_add_u32 s38, s38, 0x780000
    s_add_u32 s39, s38, 4096
    s_nop 3
    v_pk_mul_f32 v[72:73], v[72:73], v[138:139]
    v_pk_mul_f32 v[74:75], v[74:75], v[138:139]
    v_pk_mul_f32 v[76:77], v[76:77], v[138:139]
    v_pk_mul_f32 v[78:79], v[78:79], v[138:139]
    v_cvt_pk_bf16_f32 v72, v72, v73
    v_cvt_pk_bf16_f32 v73, v74, v75
    v_cvt_pk_bf16_f32 v74, v76, v77
    v_cvt_pk_bf16_f32 v75, v78, v79
    v_pk_max_i16 v72, v72, 0
    v_pk_max_i16 v73, v73, 0
    v_pk_max_i16 v74, v74, 0
    v_pk_max_i16 v75, v75, 0
    v_pk_mul_f32 v[80:81], v[80:81], v[138:139]
    v_pk_mul_f32 v[82:83], v[82:83], v[138:139]
    v_pk_mul_f32 v[84:85], v[84:85], v[138:139]
    v_pk_mul_f32 v[86:87], v[86:87], v[138:139]
    v_cvt_pk_bf16_f32 v80, v80, v81
    v_cvt_pk_bf16_f32 v81, v82, v83
    v_cvt_pk_bf16_f32 v82, v84, v85
    v_cvt_pk_bf16_f32 v83, v86, v87
    v_pk_max_i16 v80, v80, 0
    v_pk_max_i16 v81, v81, 0
    v_pk_max_i16 v82, v82, 0
    v_pk_max_i16 v83, v83, 0
    v_pk_mul_f32 v[88:89], v[88:89], v[138:139]
    v_pk_mul_f32 v[90:91], v[90:91], v[138:139]
    v_pk_mul_f32 v[92:93], v[92:93], v[138:139]
    v_pk_mul_f32 v[94:95], v[94:95], v[138:139]
    v_cvt_pk_bf16_f32 v88, v88, v89
    v_cvt_pk_bf16_f32 v89, v90, v91
    v_cvt_pk_bf16_f32 v90, v92, v93
    v_cvt_pk_bf16_f32 v91, v94, v95
    v_pk_max_i16 v88, v88, 0
    v_pk_max_i16 v89, v89, 0
    v_pk_max_i16 v90, v90, 0
    v_pk_max_i16 v91, v91, 0
    v_pk_mul_f32 v[96:97], v[96:97], v[138:139]
    v_pk_mul_f32 v[98:99], v[98:99], v[138:139]
    v_pk_mul_f32 v[100:101], v[100:101], v[138:139]
    v_pk_mul_f32 v[102:103], v[102:103], v[138:139]
    v_cvt_pk_bf16_f32 v96, v96, v97
    v_cvt_pk_bf16_f32 v97, v98, v99
    v_cvt_pk_bf16_f32 v98, v100, v101
    v_cvt_pk_bf16_f32 v99, v102, v103
    v_pk_max_i16 v96, v96, 0
    v_pk_max_i16 v97, v97, 0
    v_pk_max_i16 v98, v98, 0
    v_pk_max_i16 v99, v99, 0
    v_pk_mul_f32 v[104:105], v[104:105], v[138:139]
    v_pk_mul_f32 v[106:107], v[106:107], v[138:139]
    v_pk_mul_f32 v[108:109], v[108:109], v[138:139]
    v_pk_mul_f32 v[110:111], v[110:111], v[138:139]
    v_cvt_pk_bf16_f32 v104, v104, v105
    v_cvt_pk_bf16_f32 v105, v106, v107
    v_cvt_pk_bf16_f32 v106, v108, v109
    v_cvt_pk_bf16_f32 v107, v110, v111
    v_pk_max_i16 v104, v104, 0
    v_pk_max_i16 v105, v105, 0
    v_pk_max_i16 v106, v106, 0
    v_pk_max_i16 v107, v107, 0
    v_pk_mul_f32 v[112:113], v[112:113], v[138:139]
    v_pk_mul_f32 v[114:115], v[114:115], v[138:139]
    v_pk_mul_f32 v[116:117], v[116:117], v[138:139]
    v_pk_mul_f32 v[118:119], v[118:119], v[138:139]
    v_cvt_pk_bf16_f32 v112, v112, v113
    v_cvt_pk_bf16_f32 v113, v114, v115
    v_cvt_pk_bf16_f32 v114, v116, v117
    v_cvt_pk_bf16_f32 v115, v118, v119
    v_pk_max_i16 v112, v112, 0
    v_pk_max_i16 v113, v113, 0
    v_pk_max_i16 v114, v114, 0
    v_pk_max_i16 v115, v115, 0
    v_mov_b32 v166, v136
    s_mov_b32 s56, s38
    s_mov_b32 s57, s39
    s_add_u32 s3, s52, 0x20000
    s_mov_b32 s28, s14
    s_mov_b32 s29, s15
    s_mov_b32 s30, 0x1e0000
    s_mov_b32 s31, 0x20000
    s_mov_b32 s32, s16
    s_mov_b32 s33, s17
    s_mov_b32 s34, 0x280000
    s_mov_b32 s35, 0x20000
    s_movk_i32 s38, 6554
    v_add_u32 v108, 0, v0
    v_mul_u32_u24 v109, s38, v108
    v_lshrrev_b32 v109, 16, v109
    v_mul_u32_u24 v110, 10, v109
    v_sub_u32 v108, v108, v110
    v_and_b32 v110, 0x13, v109
    v_and_b32 v158, 4, v109
    v_lshl_or_b32 v110, v158, 1, v110
    v_and_b32 v158, 8, v109
    v_lshrrev_b32 v158, 1, v158
    v_or_b32 v109, v110, v158
    v_mul_u32_u24 v109, 1280, v109
    v_lshl_add_u32 v158, v108, 4, v109
    v_add_u32 v108, 64, v0
    v_mul_u32_u24 v109, s38, v108
    v_lshrrev_b32 v109, 16, v109
    v_mul_u32_u24 v110, 10, v109
    v_sub_u32 v108, v108, v110
    v_and_b32 v110, 0x13, v109
    v_and_b32 v159, 4, v109
    v_lshl_or_b32 v110, v159, 1, v110
    v_and_b32 v159, 8, v109
    v_lshrrev_b32 v159, 1, v159
    v_or_b32 v109, v110, v159
    v_mul_u32_u24 v109, 1280, v109
    v_lshl_add_u32 v159, v108, 4, v109
    v_subrev_u32 v159, 1024, v159
    v_add_u32 v108, 128, v0
    v_mul_u32_u24 v109, s38, v108
    v_lshrrev_b32 v109, 16, v109
    v_mul_u32_u24 v110, 10, v109
    v_sub_u32 v108, v108, v110
    v_and_b32 v110, 0x13, v109
    v_and_b32 v160, 4, v109
    v_lshl_or_b32 v110, v160, 1, v110
    v_and_b32 v160, 8, v109
    v_lshrrev_b32 v160, 1, v160
    v_or_b32 v109, v110, v160
    v_mul_u32_u24 v109, 1280, v109
    v_lshl_add_u32 v160, v108, 4, v109
    v_subrev_u32 v160, 2048, v160
    v_add_u32 v108, 192, v0
    v_mul_u32_u24 v109, s38, v108
    v_lshrrev_b32 v109, 16, v109
    v_mul_u32_u24 v110, 10, v109
    v_sub_u32 v108, v108, v110
    v_and_b32 v110, 0x13, v109
    v_and_b32 v161, 4, v109
    v_lshl_or_b32 v110, v161, 1, v110
    v_and_b32 v161, 8, v109
    v_lshrrev_b32 v161, 1, v161
    v_or_b32 v109, v110, v161
    v_mul_u32_u24 v109, 1280, v109
    v_lshl_add_u32 v161, v108, 4, v109
    v_subrev_u32 v161, 3072, v161
    v_add_u32 v108, 256, v0
    v_mul_u32_u24 v109, s38, v108
    v_lshrrev_b32 v109, 16, v109
    v_mul_u32_u24 v110, 10, v109
    v_sub_u32 v108, v108, v110
    v_and_b32 v110, 0x13, v109
    v_and_b32 v162, 4, v109
    v_lshl_or_b32 v110, v162, 1, v110
    v_and_b32 v162, 8, v109
    v_lshrrev_b32 v162, 1, v162
    v_or_b32 v109, v110, v162
    v_mul_u32_u24 v109, 1280, v109
    v_lshl_add_u32 v162, v108, 4, v109
    s_and_b32 s38, s2, 7
    s_lshl_b32 s38, s38, 2
    s_bfe_u32 s40, s2, 0x20003
    s_add_u32 s38, s38, s40
    s_lshr_b32 s39, s2, 5
    s_mov_b32 s51, 0
    s_mov_b32 s54, s51
    s_mov_b32 s52, 12
    s_mov_b32 s53, 0
    s_sub_u32 s61, s39, 5
    s_cselect_b32 s61, s39, s61
    s_mul_i32 s39, s39, 160
    s_mul_i32 s49, s46, 40960
    s_add_u32 s49, s49, s39
    s_mul_i32 s62, s46, 5120
    s_lshl_b32 s38, s38, 2
    s_add_u32 s38, s38, s46
    s_mul_i32 s48, s38, 20480
    s_add_u32 s48, s48, s39
    s_lshr_b32 s40, s38, 1
    s_and_b32 s38, s38, 1
    s_lshl_b32 s38, s38, 8
    s_mul_i32 s47, s40, 40960
    s_add_u32 s47, s47, s38
    s_add_u32 s47, s47, 0xd80000
    s_lshl_b32 s63, s40, 12
    s_and_b32 s40, s40, -2
    s_mul_i32 s55, s40, 98304
    s_lshl_b32 s38, s46, 11
    s_add_u32 s55, s55, s38
    s_add_u32 s55, s55, 0x780000
    s_lshl_b32 s41, s40, 11
    s_add_u32 s63, s63, 0x1670000
    s_add_u32 s41, s41, 0x1630000
    v_and_b32 v108, 15, v0
    v_lshrrev_b32 v109, 4, v0
    v_and_b32 v7, 31, v0
    v_lshlrev_b32 v7, 7, v7
    v_lshlrev_b32 v1, 4, v108
    v_lshrrev_b32 v110, 5, v0
    v_mul_u32_u24 v2, 1280, v108
    v_lshl_add_u32 v5, v110, 4, v2
    v_lshlrev_b32 v3, 4, v110
    v_and_b32 v110, 1, v109
    v_lshl_add_u32 v5, v110, 5, v5
    v_lshl_add_u32 v3, v110, 2, v3
    v_lshl_add_u32 v1, v109, 9, v1
    v_lshl_add_u32 v2, v109, 3, v2
    v_bfe_u32 v110, v0, 2, 2
    v_add_u32 v3, v3, v110
    v_mul_u32_u24 v3, 160, v3
    v_and_b32 v110, 3, v0
    v_lshl_add_u32 v3, v110, 3, v3
    v_add_u32 v4, 107520, v3
    v_add_u32 v3, 66560, v3
    v_mov_b32 v6, v3
    v_lshlrev_b32 v163, 2, v110
    v_add_u32 v163, 161808, v163
    s_lshl_b32 s38, s46, 2
    s_add_u32 s38, s38, 161808
    v_mov_b32 v165, s38
    s_add_u32 s38, s46, 0
    s_and_b32 s39, s38, 1
    s_bfe_u32 s38, s38, 0x10001
    s_mul_i32 s38, s38, 98304
    s_lshl_b32 s39, s39, 8
    s_add_u32 s38, s38, s39
    s_add_u32 s64, s38, s55
    s_add_u32 s38, s46, 1
    s_and_b32 s39, s38, 1
    s_bfe_u32 s38, s38, 0x10001
    s_mul_i32 s38, s38, 98304
    s_lshl_b32 s39, s39, 8
    s_add_u32 s38, s38, s39
    s_add_u32 s65, s38, s55
    s_add_u32 s38, s46, 2
    s_and_b32 s39, s38, 1
    s_bfe_u32 s38, s38, 0x10001
    s_mul_i32 s38, s38, 98304
    s_lshl_b32 s39, s39, 8
    s_add_u32 s38, s38, s39
    s_add_u32 s66, s38, s55
    s_add_u32 s38, s46, 3
    s_and_b32 s39, s38, 1
    s_bfe_u32 s38, s38, 0x10001
    s_mul_i32 s38, s38, 98304
    s_lshl_b32 s39, s39, 8
    s_add_u32 s38, s38, s39
    s_add_u32 s67, s38, s55
    v_add_u32 v156, s62, v3
    v_mov_b32 v8, 0
    v_mov_b32 v9, 0
    v_mov_b32 v10, 0
    v_mov_b32 v11, 0
    v_mov_b32 v12, 0
    v_mov_b32 v13, 0
    v_mov_b32 v14, 0
    v_mov_b32 v15, 0
    v_mov_b32 v16, 0
    v_mov_b32 v17, 0
    v_mov_b32 v18, 0
    v_mov_b32 v19, 0
    v_mov_b32 v20, 0
    v_mov_b32 v21, 0
    v_mov_b32 v22, 0
    v_mov_b32 v23, 0
    v_mov_b32 v24, 0
    v_mov_b32 v25, 0
    v_mov_b32 v26, 0
    v_mov_b32 v27, 0
    v_mov_b32 v28, 0
    v_mov_b32 v29, 0
    v_mov_b32 v30, 0
    v_mov_b32 v31, 0
    v_mov_b32 v32, 0
    v_mov_b32 v33, 0
    v_mov_b32 v34, 0
    v_mov_b32 v35, 0
    v_mov_b32 v36, 0
    v_mov_b32 v37, 0
    v_mov_b32 v38, 0
    v_mov_b32 v39, 0
    v_mov_b32 v40, 0
    v_mov_b32 v41, 0
    v_mov_b32 v42, 0
    v_mov_b32 v43, 0
    v_mov_b32 v44, 0
    v_mov_b32 v45, 0
    v_mov_b32 v46, 0
    v_mov_b32 v47, 0
    v_mov_b32 v48, 0
    v_mov_b32 v49, 0
    v_mov_b32 v50, 0
    v_mov_b32 v51, 0
    v_mov_b32 v52, 0
    v_mov_b32 v53, 0
    v_mov_b32 v54, 0
    v_mov_b32 v55, 0
    v_mov_b32 v56, 0
    v_mov_b32 v57, 0
    v_mov_b32 v58, 0
    v_mov_b32 v59, 0
    v_mov_b32 v60, 0
    v_mov_b32 v61, 0
    v_mov_b32 v62, 0
    v_mov_b32 v63, 0
    v_mov_b32 v64, 0
    v_mov_b32 v65, 0
    v_mov_b32 v66, 0
    v_mov_b32 v67, 0
    v_mov_b32 v68, 0
    v_mov_b32 v69, 0
    v_mov_b32 v70, 0
    v_mov_b32 v71, 0
    s_mov_b32 s50, s37
    v_mov_b32 v164, s50
    ds_write_b32 v165, v164
    s_mov_b32 s43, 0
L_mt_23:
    ds_read_b32 v164, v163
    s_add_u32 s43, s43, 1
    s_waitcnt lgkmcnt(0)
    v_subrev_u32 v164, s50, v164
    v_cmp_lt_u32 s[58:59], 1, v164
    s_cmp_eq_u64 s[58:59], 0
    s_cbranch_scc1 L_mtd_24
    s_sleep 2
    s_cmp_lt_u32 s43, 1048576
    s_cbranch_scc1 L_mt_23
L_mtd_24:
    s_add_u32 s50, s50, 1
    buffer_load_dword v110, v7, s[24:27], s41 offen sc1
    v_and_b32 v108, 3, v0
    v_lshlrev_b32 v108, 2, v108
    v_add_u32 v108, 161936, v108
    s_mov_b32 s43, 0
L_aw_25:
    ds_read_b32 v109, v108
    s_add_u32 s43, s43, 1
    s_waitcnt lgkmcnt(0)
    v_cmp_ne_u32 vcc, s37, v109
    s_cmp_eq_u64 vcc, 0
    s_cbranch_scc1 L_awd_26
    s_sleep 4
    s_cmp_lt_u32 s43, 1048576
    s_cbranch_scc1 L_aw_25
L_awd_26:
    buffer_store_dwordx4 v[72:75], v166, s[24:27], s56 offen offset:0 sc1
    buffer_store_dwordx4 v[80:83], v166, s[24:27], s56 offen offset:1024 sc1
    buffer_store_dwordx4 v[88:91], v166, s[24:27], s56 offen offset:2048 sc1
    buffer_store_dwordx4 v[96:99], v166, s[24:27], s56 offen offset:3072 sc1
    buffer_store_dwordx4 v[104:107], v166, s[24:27], s57 offen offset:0 sc1
    buffer_store_dwordx4 v[112:115], v166, s[24:27], s57 offen offset:1024 sc1
    v_and_b32 v108, 7, v0
    v_lshlrev_b32 v108, 2, v108
    v_add_u32 v108, 161936, v108
    s_waitcnt vmcnt(0)
    v_mov_b32 v109, s37
    s_mov_b64 exec, 0x1
    buffer_store_dword v109, off, s[24:27], s3 sc1
    s_mov_b64 exec, -1
    v_mov_b32 v72, 0
    v_mov_b32 v73, 0
    v_mov_b32 v74, 0
    v_mov_b32 v75, 0
    v_mov_b32 v76, 0
    v_mov_b32 v77, 0
    v_mov_b32 v78, 0
    v_mov_b32 v79, 0
    v_mov_b32 v80, 0
    v_mov_b32 v81, 0
    v_mov_b32 v82, 0
    v_mov_b32 v83, 0
    v_mov_b32 v84, 0
    v_mov_b32 v85, 0
    v_mov_b32 v86, 0
    v_mov_b32 v87, 0
    s_mov_b32 s43, 0
L_aw_27:
    ds_read_b32 v109, v108
    s_add_u32 s43, s43, 1
    s_waitcnt lgkmcnt(0)
    v_cmp_ne_u32 vcc, s37, v109
    s_cmp_eq_u64 vcc, 0
    s_cbranch_scc1 L_awd_28
    s_sleep 4
    s_cmp_lt_u32 s43, 1048576
    s_cbranch_scc1 L_aw_27
L_awd_28:
    s_mul_i32 s60, s51, 163840
    s_add_u32 s60, s60, s49
    s_add_u32 m0, s62, 66560
    s_add_u32 s51, s51, 1
    buffer_load_dwordx4 v158, s[28:31], s60 offen offset:0 lds
    buffer_load_dwordx4 v159, s[28:31], s60 offen offset:1024 lds
    buffer_load_dwordx4 v160, s[28:31], s60 offen offset:2048 lds
    buffer_load_dwordx4 v161, s[28:31], s60 offen offset:3072 lds
    s_add_u32 m0, m0, 4096
    s_cmp_eq_u32 s51, s52
    buffer_load_dwordx4 v162, s[28:31], s60 offen lds
    s_cselect_b32 s51, 0, s51
    s_mov_b32 s6, 2621440
    s_mov_b32 s7, 0x20000
    s_mov_b32 s43, 0
L_poll_29:
    buffer_load_dword v108, v7, s[24:27], s41 offen sc1
    s_add_u32 s43, s43, 1
    s_waitcnt vmcnt(0)
    v_xor_b32 v108, s37, v108
    v_cmp_ne_u32 vcc, 0, v108
    s_cmp_eq_u64 vcc, 0
    s_cbranch_scc1 L_polld_30
    s_sleep 1
    s_cmp_lt_u32 s43, 65536
    s_cbranch_scc1 L_poll_29
L_polld_30:
    buffer_load_dwordx4 v[108:111], v1, s[24:27], s64 offen sc1
    s_add_u32 s64, s64, 8192
    buffer_load_dwordx4 v[112:115], v1, s[24:27], s65 offen sc1
    s_add_u32 s65, s65, 8192
    buffer_load_dwordx4 v[116:119], v1, s[24:27], s66 offen sc1
    s_add_u32 s66, s66, 8192
    buffer_load_dwordx4 v[120:123], v1, s[24:27], s67 offen sc1
    s_add_u32 s67, s67, 8192
    s_mul_i32 s60, s51, 163840
    s_add_u32 s60, s60, s49
    s_add_u32 m0, s62, 87040
    s_add_u32 s51, s51, 1
    buffer_load_dwordx4 v158, s[28:31], s60 offen offset:0 lds
    buffer_load_dwordx4 v159, s[28:31], s60 offen offset:1024 lds
    buffer_load_dwordx4 v160, s[28:31], s60 offen offset:2048 lds
    buffer_load_dwordx4 v161, s[28:31], s60 offen offset:3072 lds
    s_add_u32 m0, m0, 4096
    s_cmp_eq_u32 s51, s52
    buffer_load_dwordx4 v162, s[28:31], s60 offen lds
    s_cselect_b32 s51, 0, s51
    buffer_load_dwordx4 v[124:127], v1, s[24:27], s64 offen sc1
    s_add_u32 s64, s64, 8192
    buffer_load_dwordx4 v[128:131], v1, s[24:27], s65 offen sc1
    s_add_u32 s65, s65, 8192
    buffer_load_dwordx4 v[132:135], v1, s[24:27], s66 offen sc1
    s_add_u32 s66, s66, 8192
    buffer_load_dwordx4 v[136:139], v1, s[24:27], s67 offen sc1
    s_add_u32 s67, s67, 8192
    s_mul_i32 s60, s51, 163840
    s_add_u32 s60, s60, s49
    s_add_u32 m0, s62, 107520
    s_add_u32 s51, s51, 1
    buffer_load_dwordx4 v158, s[28:31], s60 offen offset:0 lds
    buffer_load_dwordx4 v159, s[28:31], s60 offen offset:1024 lds
    buffer_load_dwordx4 v160, s[28:31], s60 offen offset:2048 lds
    buffer_load_dwordx4 v161, s[28:31], s60 offen offset:3072 lds
    s_add_u32 m0, m0, 4096
    s_cmp_eq_u32 s51, s52
    buffer_load_dwordx4 v162, s[28:31], s60 offen lds
    s_cselect_b32 s51, 0, s51
    ds_read_b64_tr_b16 v[88:89], v156 offset:0
    ds_read_b64_tr_b16 v[90:91], v156 offset:1280
    ds_read_b64_tr_b16 v[92:93], v156 offset:32
    ds_read_b64_tr_b16 v[94:95], v156 offset:1312
    ds_read_b64_tr_b16 v[96:97], v156 offset:64
    ds_read_b64_tr_b16 v[98:99], v156 offset:1344
    ds_read_b64_tr_b16 v[100:101], v156 offset:96
    ds_read_b64_tr_b16 v[102:103], v156 offset:1376
    ds_read_b64_tr_b16 v[104:105], v156 offset:128
    ds_read_b64_tr_b16 v[106:107], v156 offset:1408
    s_mov_b32 s53, 0
    s_mov_b32 s10, 128000
.p2align 6
L_m2:
    s_add_u32 s53, s53, 1
    s_and_b32 s38, s53, 3
    s_cselect_b32 s38, 1, -3
    s_mul_i32 s38, s38, 20480
    v_add_u32 v156, s38, v156
    s_cmp_lg_u32 s53, 10
    s_cbranch_scc1 L_m2_same
    s_mov_b32 s28, s8
    s_mov_b32 s29, s9
    s_mov_b32 s30, 0xc8000
    s_mov_b32 s31, 0x20000
    s_mov_b32 s51, s61
    s_mov_b32 s52, 5
    s_lshr_b32 s39, s2, 3
    s_lshl2_add_u32 s39, s39, s46
    s_mul_i32 s39, s39, 6400
    v_lshlrev_b32 v157, 7, v0
    s_mov_b32 exec_hi, 0x3ffff
    buffer_load_dword v167, v157, s[28:31], s39 offen
    buffer_load_dword v167, v157, s[28:31], s39 offen offset:64
    s_mov_b64 exec, -1
L_m2_same:
    s_waitcnt vmcnt(9) lgkmcnt(8)
    v_mfma_f32_16x16x32_bf16 v[8:11], v[88:91], v[108:111], v[8:11]
    v_mfma_f32_16x16x32_bf16 v[28:31], v[88:91], v[112:115], v[28:31]
    v_mfma_f32_16x16x32_bf16 v[48:51], v[88:91], v[116:119], v[48:51]
    v_mfma_f32_16x16x32_bf16 v[68:71], v[88:91], v[120:123], v[68:71]
    ds_read_b64_tr_b16 v[88:89], v156 offset:0
    ds_read_b64_tr_b16 v[90:91], v156 offset:1280
    buffer_load_dwordx4 v[140:143], v1, s[24:27], s64 offen sc1
    s_add_u32 s64, s64, 8192
    buffer_load_dwordx4 v[144:147], v1, s[24:27], s65 offen sc1
    s_add_u32 s65, s65, 8192
    s_waitcnt lgkmcnt(8)
    v_mfma_f32_16x16x32_bf16 v[12:15], v[92:95], v[108:111], v[12:15]
    v_mfma_f32_16x16x32_bf16 v[32:35], v[92:95], v[112:115], v[32:35]
    v_mfma_f32_16x16x32_bf16 v[52:55], v[92:95], v[116:119], v[52:55]
    v_mfma_f32_16x16x32_bf16 v[72:75], v[92:95], v[120:123], v[72:75]
    ds_read_b64_tr_b16 v[92:93], v156 offset:32
    ds_read_b64_tr_b16 v[94:95], v156 offset:1312
    buffer_load_dwordx4 v[148:151], v1, s[24:27], s66 offen sc1
    s_add_u32 s66, s66, 8192
    buffer_load_dwordx4 v[152:155], v1, s[24:27], s67 offen sc1
    s_add_u32 s67, s67, 8192
    s_waitcnt lgkmcnt(8)
    v_mfma_f32_16x16x32_bf16 v[16:19], v[96:99], v[108:111], v[16:19]
    v_mfma_f32_16x16x32_bf16 v[36:39], v[96:99], v[112:115], v[36:39]
    v_mfma_f32_16x16x32_bf16 v[56:59], v[96:99], v[116:119], v[56:59]
    v_mfma_f32_16x16x32_bf16 v[76:79], v[96:99], v[120:123], v[76:79]
    ds_read_b64_tr_b16 v[96:97], v156 offset:64
    ds_read_b64_tr_b16 v[98:99], v156 offset:1344
    s_mul_i32 s60, s51, 163840
    s_add_u32 s60, s60, s49
    s_add_u32 m0, s62, s10
    s_add_u32 s51, s51, 1
    buffer_load_dwordx4 v158, s[28:31], s60 offen offset:0 lds
    buffer_load_dwordx4 v159, s[28:31], s60 offen offset:1024 lds
    s_waitcnt lgkmcnt(8)
    v_mfma_f32_16x16x32_bf16 v[20:23], v[100:103], v[108:111], v[20:23]
    v_mfma_f32_16x16x32_bf16 v[40:43], v[100:103], v[112:115], v[40:43]
    v_mfma_f32_16x16x32_bf16 v[60:63], v[100:103], v[116:119], v[60:63]
    v_mfma_f32_16x16x32_bf16 v[80:83], v[100:103], v[120:123], v[80:83]
    ds_read_b64_tr_b16 v[100:101], v156 offset:96
    ds_read_b64_tr_b16 v[102:103], v156 offset:1376
    buffer_load_dwordx4 v160, s[28:31], s60 offen offset:2048 lds
    buffer_load_dwordx4 v161, s[28:31], s60 offen offset:3072 lds
    s_waitcnt lgkmcnt(8)
    v_mfma_f32_16x16x32_bf16 v[24:27], v[104:107], v[108:111], v[24:27]
    v_mfma_f32_16x16x32_bf16 v[44:47], v[104:107], v[112:115], v[44:47]
    v_mfma_f32_16x16x32_bf16 v[64:67], v[104:107], v[116:119], v[64:67]
    v_mfma_f32_16x16x32_bf16 v[84:87], v[104:107], v[120:123], v[84:87]
    ds_read_b64_tr_b16 v[104:105], v156 offset:128
    ds_read_b64_tr_b16 v[106:107], v156 offset:1408
    s_add_u32 m0, m0, 4096
    s_cmp_eq_u32 s51, s52
    buffer_load_dwordx4 v162, s[28:31], s60 offen lds
    s_cselect_b32 s51, 0, s51
    s_add_u32 s10, s10, 20480
    s_cmp_eq_u32 s10, 148480
    s_cselect_b32 s10, 66560, s10
    s_add_u32 s53, s53, 1
    s_and_b32 s38, s53, 3
    s_cselect_b32 s38, 1, -3
    s_mul_i32 s38, s38, 20480
    v_add_u32 v156, s38, v156
    s_cmp_eq_u32 s53, 11
    s_cselect_b64 vcc, -1, 0
    s_waitcnt vmcnt(9) lgkmcnt(8)
    v_mfma_f32_16x16x32_bf16 v[8:11], v[88:91], v[124:127], v[8:11]
    v_mfma_f32_16x16x32_bf16 v[28:31], v[88:91], v[128:131], v[28:31]
    v_mfma_f32_16x16x32_bf16 v[48:51], v[88:91], v[132:135], v[48:51]
    v_mfma_f32_16x16x32_bf16 v[68:71], v[88:91], v[136:139], v[68:71]
    ds_read_b64_tr_b16 v[88:89], v156 offset:0
    ds_read_b64_tr_b16 v[90:91], v156 offset:1280
    s_cbranch_vccnz L_m2_n10
    buffer_load_dwordx4 v[108:111], v1, s[24:27], s64 offen sc1
    s_add_u32 s64, s64, 8192
    buffer_load_dwordx4 v[112:115], v1, s[24:27], s65 offen sc1
    s_add_u32 s65, s65, 8192
L_m2_n10:
    s_waitcnt lgkmcnt(8)
    v_mfma_f32_16x16x32_bf16 v[12:15], v[92:95], v[124:127], v[12:15]
    v_mfma_f32_16x16x32_bf16 v[32:35], v[92:95], v[128:131], v[32:35]
    v_mfma_f32_16x16x32_bf16 v[52:55], v[92:95], v[132:135], v[52:55]
    v_mfma_f32_16x16x32_bf16 v[72:75], v[92:95], v[136:139], v[72:75]
    ds_read_b64_tr_b16 v[92:93], v156 offset:32
    ds_read_b64_tr_b16 v[94:95], v156 offset:1312
    s_cbranch_vccnz L_m2_n11
    buffer_load_dwordx4 v[116:119], v1, s[24:27], s66 offen sc1
    s_add_u32 s66, s66, 8192
    buffer_load_dwordx4 v[120:123], v1, s[24:27], s67 offen sc1
    s_add_u32 s67, s67, 8192
L_m2_n11:
    s_waitcnt lgkmcnt(8)
    v_mfma_f32_16x16x32_bf16 v[16:19], v[96:99], v[124:127], v[16:19]
    v_mfma_f32_16x16x32_bf16 v[36:39], v[96:99], v[128:131], v[36:39]
    v_mfma_f32_16x16x32_bf16 v[56:59], v[96:99], v[132:135], v[56:59]
    v_mfma_f32_16x16x32_bf16 v[76:79], v[96:99], v[136:139], v[76:79]
    ds_read_b64_tr_b16 v[96:97], v156 offset:64
    ds_read_b64_tr_b16 v[98:99], v156 offset:1344
    s_cbranch_vccnz L_m2_n12
    s_mul_i32 s60, s51, 163840
    s_add_u32 s60, s60, s49
    s_add_u32 m0, s62, s10
    s_add_u32 s51, s51, 1
    buffer_load_dwordx4 v158, s[28:31], s60 offen offset:0 lds
    buffer_load_dwordx4 v159, s[28:31], s60 offen offset:1024 lds
L_m2_n12:
    s_waitcnt lgkmcnt(8)
    v_mfma_f32_16x16x32_bf16 v[20:23], v[100:103], v[124:127], v[20:23]
    v_mfma_f32_16x16x32_bf16 v[40:43], v[100:103], v[128:131], v[40:43]
    v_mfma_f32_16x16x32_bf16 v[60:63], v[100:103], v[132:135], v[60:63]
    v_mfma_f32_16x16x32_bf16 v[80:83], v[100:103], v[136:139], v[80:83]
    ds_read_b64_tr_b16 v[100:101], v156 offset:96
    ds_read_b64_tr_b16 v[102:103], v156 offset:1376
    s_cbranch_vccnz L_m2_n13
    buffer_load_dwordx4 v160, s[28:31], s60 offen offset:2048 lds
    buffer_load_dwordx4 v161, s[28:31], s60 offen offset:3072 lds
L_m2_n13:
    s_waitcnt lgkmcnt(8)
    v_mfma_f32_16x16x32_bf16 v[24:27], v[104:107], v[124:127], v[24:27]
    v_mfma_f32_16x16x32_bf16 v[44:47], v[104:107], v[128:131], v[44:47]
    v_mfma_f32_16x16x32_bf16 v[64:67], v[104:107], v[132:135], v[64:67]
    v_mfma_f32_16x16x32_bf16 v[84:87], v[104:107], v[136:139], v[84:87]
    ds_read_b64_tr_b16 v[104:105], v156 offset:128
    ds_read_b64_tr_b16 v[106:107], v156 offset:1408
    s_cbranch_vccnz L_m2_n14
    s_add_u32 m0, m0, 4096
    s_cmp_eq_u32 s51, s52
    buffer_load_dwordx4 v162, s[28:31], s60 offen lds
    s_cselect_b32 s51, 0, s51
    s_add_u32 s10, s10, 20480
    s_cmp_eq_u32 s10, 148480
    s_cselect_b32 s10, 66560, s10
L_m2_n14:
    s_add_u32 s53, s53, 1
    s_and_b32 s38, s53, 3
    s_cselect_b32 s38, 1, -3
    s_mul_i32 s38, s38, 20480
    v_add_u32 v156, s38, v156
    s_waitcnt vmcnt(9) lgkmcnt(8)
    s_cbranch_vccz L_m2_go
    s_waitcnt vmcnt(0)
    buffer_load_dwordx2 v[108:109], v2, s[4:7], s48 offen offset:0
    buffer_load_dwordx2 v[110:111], v2, s[4:7], s48 offen offset:32
    buffer_load_dwordx2 v[112:113], v2, s[4:7], s48 offen offset:64
    buffer_load_dwordx2 v[114:115], v2, s[4:7], s48 offen offset:96
    buffer_load_dwordx2 v[116:117], v2, s[4:7], s48 offen offset:128
    buffer_load_dword v167, v7, s[24:27], s63 offen sc1
L_m2_go:
    v_mfma_f32_16x16x32_bf16 v[8:11], v[88:91], v[140:143], v[8:11]
    v_mfma_f32_16x16x32_bf16 v[28:31], v[88:91], v[144:147], v[28:31]
    v_mfma_f32_16x16x32_bf16 v[48:51], v[88:91], v[148:151], v[48:51]
    v_mfma_f32_16x16x32_bf16 v[68:71], v[88:91], v[152:155], v[68:71]
    ds_read_b64_tr_b16 v[88:89], v156 offset:0
    ds_read_b64_tr_b16 v[90:91], v156 offset:1280
    s_cbranch_vccnz L_m2_n20
    buffer_load_dwordx4 v[124:127], v1, s[24:27], s64 offen sc1
    s_add_u32 s64, s64, 8192
    buffer_load_dwordx4 v[128:131], v1, s[24:27], s65 offen sc1
    s_add_u32 s65, s65, 8192
L_m2_n20:
    s_waitcnt lgkmcnt(8)
    v_mfma_f32_16x16x32_bf16 v[12:15], v[92:95], v[140:143], v[12:15]
    v_mfma_f32_16x16x32_bf16 v[32:35], v[92:95], v[144:147], v[32:35]
    v_mfma_f32_16x16x32_bf16 v[52:55], v[92:95], v[148:151], v[52:55]
    v_mfma_f32_16x16x32_bf16 v[72:75], v[92:95], v[152:155], v[72:75]
    ds_read_b64_tr_b16 v[92:93], v156 offset:32
    ds_read_b64_tr_b16 v[94:95], v156 offset:1312
    s_cbranch_vccnz L_m2_n21
    buffer_load_dwordx4 v[132:135], v1, s[24:27], s66 offen sc1
    s_add_u32 s66, s66, 8192
    buffer_load_dwordx4 v[136:139], v1, s[24:27], s67 offen sc1
    s_add_u32 s67, s67, 8192
L_m2_n21:
    s_waitcnt lgkmcnt(8)
    v_mfma_f32_16x16x32_bf16 v[16:19], v[96:99], v[140:143], v[16:19]
    v_mfma_f32_16x16x32_bf16 v[36:39], v[96:99], v[144:147], v[36:39]
    v_mfma_f32_16x16x32_bf16 v[56:59], v[96:99], v[148:151], v[56:59]
    v_mfma_f32_16x16x32_bf16 v[76:79], v[96:99], v[152:155], v[76:79]
    ds_read_b64_tr_b16 v[96:97], v156 offset:64
    ds_read_b64_tr_b16 v[98:99], v156 offset:1344
    s_cbranch_vccnz L_m2_n22
    s_mul_i32 s60, s51, 163840
    s_add_u32 s60, s60, s49
    s_add_u32 m0, s62, s10
    s_add_u32 s51, s51, 1
    buffer_load_dwordx4 v158, s[28:31], s60 offen offset:0 lds
    buffer_load_dwordx4 v159, s[28:31], s60 offen offset:1024 lds
L_m2_n22:
    s_waitcnt lgkmcnt(8)
    v_mfma_f32_16x16x32_bf16 v[20:23], v[100:103], v[140:143], v[20:23]
    v_mfma_f32_16x16x32_bf16 v[40:43], v[100:103], v[144:147], v[40:43]
    v_mfma_f32_16x16x32_bf16 v[60:63], v[100:103], v[148:151], v[60:63]
    v_mfma_f32_16x16x32_bf16 v[80:83], v[100:103], v[152:155], v[80:83]
    ds_read_b64_tr_b16 v[100:101], v156 offset:96
    ds_read_b64_tr_b16 v[102:103], v156 offset:1376
    s_cbranch_vccnz L_m2_n23
    buffer_load_dwordx4 v160, s[28:31], s60 offen offset:2048 lds
    buffer_load_dwordx4 v161, s[28:31], s60 offen offset:3072 lds
L_m2_n23:
    s_waitcnt lgkmcnt(8)
    v_mfma_f32_16x16x32_bf16 v[24:27], v[104:107], v[140:143], v[24:27]
    v_mfma_f32_16x16x32_bf16 v[44:47], v[104:107], v[144:147], v[44:47]
    v_mfma_f32_16x16x32_bf16 v[64:67], v[104:107], v[148:151], v[64:67]
    v_mfma_f32_16x16x32_bf16 v[84:87], v[104:107], v[152:155], v[84:87]
    ds_read_b64_tr_b16 v[104:105], v156 offset:128
    ds_read_b64_tr_b16 v[106:107], v156 offset:1408
    s_cbranch_vccnz L_m2_n24
    s_add_u32 m0, m0, 4096
    s_cmp_eq_u32 s51, s52
    buffer_load_dwordx4 v162, s[28:31], s60 offen lds
    s_cselect_b32 s51, 0, s51
    s_add_u32 s10, s10, 20480
    s_cmp_eq_u32 s10, 148480
    s_cselect_b32 s10, 66560, s10
L_m2_n24:
    s_cbranch_vccz L_m2
    v_lshlrev_b32 v156, 4, v0
    s_add_u32 s38, s62, 87040
    v_add_u32 v157, s38, v156
    s_nop 3
    s_waitcnt lgkmcnt(0)
    ds_write_b128 v157, v[28:31] offset:0
    ds_write_b128 v157, v[32:35] offset:1024
    ds_write_b128 v157, v[36:39] offset:2048
    ds_write_b128 v157, v[40:43] offset:3072
    ds_write_b128 v157, v[44:47] offset:4096
    ds_write_b128 v157, v[48:51] offset:20480
    ds_write_b128 v157, v[52:55] offset:21504
    ds_write_b128 v157, v[56:59] offset:22528
    ds_write_b128 v157, v[60:63] offset:23552
    ds_write_b128 v157, v[64:67] offset:24576
    ds_write_b128 v157, v[68:71] offset:40960
    ds_write_b128 v157, v[72:75] offset:41984
    ds_write_b128 v157, v[76:79] offset:43008
    ds_write_b128 v157, v[80:83] offset:44032
    ds_write_b128 v157, v[84:87] offset:45056
    s_waitcnt lgkmcnt(0)
    v_mov_b32 v164, s50
    ds_write_b32 v165, v164
    s_mov_b32 s43, 0
L_mt_31:
    ds_read_b32 v164, v163
    s_add_u32 s43, s43, 1
    s_waitcnt lgkmcnt(0)
    v_subrev_u32 v164, s50, v164
    v_cmp_lt_u32 s[58:59], 1, v164
    s_cmp_eq_u64 s[58:59], 0
    s_cbranch_scc1 L_mtd_32
    s_sleep 2
    s_cmp_lt_u32 s43, 1048576
    s_cbranch_scc1 L_mt_31
L_mtd_32:
    s_add_u32 s50, s50, 1
    s_sub_u32 s38, s46, 1
    s_and_b32 s38, s38, 3
    s_mul_i32 s38, s38, 5120
    s_add_u32 s38, s38, 87040
    v_add_u32 v157, s38, v156
    ds_read_b128 v[28:31], v157 offset:0
    ds_read_b128 v[32:35], v157 offset:1024
    ds_read_b128 v[36:39], v157 offset:2048
    ds_read_b128 v[40:43], v157 offset:3072
    ds_read_b128 v[44:47], v157 offset:4096
    s_sub_u32 s38, s46, 2
    s_and_b32 s38, s38, 3
    s_mul_i32 s38, s38, 5120
    s_add_u32 s38, s38, 107520
    v_add_u32 v157, s38, v156
    ds_read_b128 v[48:51], v157 offset:0
    ds_read_b128 v[52:55], v157 offset:1024
    ds_read_b128 v[56:59], v157 offset:2048
    ds_read_b128 v[60:63], v157 offset:3072
    ds_read_b128 v[64:67], v157 offset:4096
    s_sub_u32 s38, s46, 3
    s_and_b32 s38, s38, 3
    s_mul_i32 s38, s38, 5120
    s_add_u32 s38, s38, 128000
    v_add_u32 v157, s38, v156
    ds_read_b128 v[68:71], v157 offset:0
    ds_read_b128 v[72:75], v157 offset:1024
    ds_read_b128 v[76:79], v157 offset:2048
    ds_read_b128 v[80:83], v157 offset:3072
    ds_read_b128 v[84:87], v157 offset:4096
    ds_read_b64_tr_b16 v[118:119], v3 offset:0
    ds_read_b64_tr_b16 v[120:121], v3 offset:1280
    ds_read_b64_tr_b16 v[122:123], v3 offset:32
    ds_read_b64_tr_b16 v[124:125], v3 offset:1312
    ds_read_b64_tr_b16 v[126:127], v3 offset:64
    ds_read_b64_tr_b16 v[128:129], v3 offset:1344
    ds_read_b64_tr_b16 v[130:131], v3 offset:96
    ds_read_b64_tr_b16 v[132:133], v3 offset:1376
    ds_read_b64_tr_b16 v[134:135], v3 offset:128
    ds_read_b64_tr_b16 v[136:137], v3 offset:1408
    ds_read_b64_tr_b16 v[138:139], v3 offset:5120
    ds_read_b64_tr_b16 v[140:141], v3 offset:6400
    ds_read_b64_tr_b16 v[142:143], v3 offset:5152
    ds_read_b64_tr_b16 v[144:145], v3 offset:6432
    ds_read_b64_tr_b16 v[146:147], v3 offset:5184
    ds_read_b64_tr_b16 v[148:149], v3 offset:6464
    ds_read_b64_tr_b16 v[150:151], v3 offset:5216
    ds_read_b64_tr_b16 v[152:153], v3 offset:6496
    ds_read_b64_tr_b16 v[154:155], v3 offset:5248
    ds_read_b64_tr_b16 v[156:157], v3 offset:6528
    s_waitcnt lgkmcnt(0)
    v_mov_b32 v164, s50
    ds_write_b32 v165, v164
    s_mov_b32 s43, 0
L_mt_33:
    ds_read_b32 v164, v163
    s_add_u32 s43, s43, 1
    s_waitcnt lgkmcnt(0)
    v_subrev_u32 v164, s50, v164
    v_cmp_lt_u32 s[58:59], 1, v164
    s_cmp_eq_u64 s[58:59], 0
    s_cbranch_scc1 L_mtd_34
    s_sleep 2
    s_cmp_lt_u32 s43, 1048576
    s_cbranch_scc1 L_mt_33
L_mtd_34:
    s_add_u32 s50, s50, 1
    s_mov_b32 s11, 0xbfb8aa3b
    s_mul_i32 s60, s51, 163840
    s_add_u32 s60, s60, s49
    s_add_u32 m0, s62, 87040
    s_add_u32 s51, s51, 1
    buffer_load_dwordx4 v158, s[28:31], s60 offen offset:0 lds
    buffer_load_dwordx4 v159, s[28:31], s60 offen offset:1024 lds
    v_add_f32 v8, v8, v28
    v_add_f32 v48, v48, v68
    v_add_f32 v9, v9, v29
    v_add_f32 v49, v49, v69
    v_add_f32 v10, v10, v30
    v_add_f32 v50, v50, v70
    v_add_f32 v11, v11, v31
    v_add_f32 v51, v51, v71
    v_add_f32 v12, v12, v32
    v_add_f32 v52, v52, v72
    v_add_f32 v13, v13, v33
    v_add_f32 v53, v53, v73
    v_add_f32 v14, v14, v34
    v_add_f32 v54, v54, v74
    v_add_f32 v15, v15, v35
    buffer_load_dwordx4 v160, s[28:31], s60 offen offset:2048 lds
    buffer_load_dwordx4 v161, s[28:31], s60 offen offset:3072 lds
    v_add_f32 v55, v55, v75
    v_add_f32 v16, v16, v36
    v_add_f32 v56, v56, v76
    v_add_f32 v17, v17, v37
    v_add_f32 v57, v57, v77
    v_add_f32 v18, v18, v38
    v_add_f32 v58, v58, v78
    v_add_f32 v19, v19, v39
    v_add_f32 v59, v59, v79
    v_add_f32 v20, v20, v40
    v_add_f32 v60, v60, v80
    v_add_f32 v21, v21, v41
    v_add_f32 v61, v61, v81
    v_add_f32 v22, v22, v42
    v_add_f32 v62, v62, v82
    s_add_u32 m0, m0, 4096
    s_cmp_eq_u32 s51, s52
    buffer_load_dwordx4 v162, s[28:31], s60 offen lds
    s_cselect_b32 s51, 0, s51
    v_add_f32 v23, v23, v43
    v_add_f32 v63, v63, v83
    v_add_f32 v24, v24, v44
    v_add_f32 v64, v64, v84
    v_add_f32 v25, v25, v45
    v_add_f32 v65, v65, v85
    v_add_f32 v26, v26, v46
    v_add_f32 v66, v66, v86
    v_add_f32 v27, v27, v47
    v_add_f32 v67, v67, v87
    v_add_f32 v28, v8, v48
    v_add_f32 v29, v9, v49
    v_add_f32 v30, v10, v50
    v_add_f32 v31, v11, v51
    v_add_f32 v32, v12, v52
    s_mul_i32 s60, s51, 163840
    s_add_u32 s60, s60, s49
    s_add_u32 m0, s62, 107520
    s_add_u32 s51, s51, 1
    buffer_load_dwordx4 v158, s[28:31], s60 offen offset:0 lds
    buffer_load_dwordx4 v159, s[28:31], s60 offen offset:1024 lds
    v_add_f32 v33, v13, v53
    v_add_f32 v34, v14, v54
    v_add_f32 v35, v15, v55
    v_add_f32 v36, v16, v56
    v_add_f32 v37, v17, v57
    v_add_f32 v38, v18, v58
    v_add_f32 v39, v19, v59
    v_add_f32 v40, v20, v60
    v_add_f32 v41, v21, v61
    v_add_f32 v42, v22, v62
    v_add_f32 v43, v23, v63
    v_add_f32 v44, v24, v64
    v_add_f32 v45, v25, v65
    v_add_f32 v46, v26, v66
    v_add_f32 v47, v27, v67
    buffer_load_dwordx4 v160, s[28:31], s60 offen offset:2048 lds
    buffer_load_dwordx4 v161, s[28:31], s60 offen offset:3072 lds
    v_mul_f32 v8, s11, v28
    v_mul_f32 v9, s11, v29
    v_mul_f32 v10, s11, v30
    v_mul_f32 v11, s11, v31
    v_mul_f32 v12, s11, v32
    v_mul_f32 v13, s11, v33
    v_mul_f32 v14, s11, v34
    v_mul_f32 v15, s11, v35
    v_mul_f32 v16, s11, v36
    v_mul_f32 v17, s11, v37
    v_mul_f32 v18, s11, v38
    v_mul_f32 v19, s11, v39
    v_mul_f32 v20, s11, v40
    v_mul_f32 v21, s11, v41
    v_mul_f32 v22, s11, v42
    s_add_u32 m0, m0, 4096
    s_cmp_eq_u32 s51, s52
    buffer_load_dwordx4 v162, s[28:31], s60 offen lds
    s_cselect_b32 s51, 0, s51
    v_mul_f32 v23, s11, v43
    v_mul_f32 v24, s11, v44
    v_mul_f32 v25, s11, v45
    v_mul_f32 v26, s11, v46
    v_mul_f32 v27, s11, v47
    v_exp_f32 v8, v8
    v_exp_f32 v9, v9
    v_exp_f32 v10, v10
    v_exp_f32 v11, v11
    v_exp_f32 v12, v12
    v_exp_f32 v13, v13
    v_exp_f32 v14, v14
    v_exp_f32 v15, v15
    v_exp_f32 v16, v16
    v_exp_f32 v17, v17
    s_mul_i32 s60, s51, 163840
    s_add_u32 s60, s60, s49
    s_add_u32 m0, s62, 128000
    s_add_u32 s51, s51, 1
    buffer_load_dwordx4 v158, s[28:31], s60 offen offset:0 lds
    buffer_load_dwordx4 v159, s[28:31], s60 offen offset:1024 lds
    v_exp_f32 v18, v18
    v_exp_f32 v19, v19
    v_exp_f32 v20, v20
    v_exp_f32 v21, v21
    v_exp_f32 v22, v22
    v_exp_f32 v23, v23
    v_exp_f32 v24, v24
    v_exp_f32 v25, v25
    v_exp_f32 v26, v26
    v_exp_f32 v27, v27
    v_add_f32 v8, 1.0, v8
    v_add_f32 v9, 1.0, v9
    v_add_f32 v10, 1.0, v10
    v_add_f32 v11, 1.0, v11
    v_add_f32 v12, 1.0, v12
    buffer_load_dwordx4 v160, s[28:31], s60 offen offset:2048 lds
    buffer_load_dwordx4 v161, s[28:31], s60 offen offset:3072 lds
    v_add_f32 v13, 1.0, v13
    v_add_f32 v14, 1.0, v14
    v_add_f32 v15, 1.0, v15
    v_add_f32 v16, 1.0, v16
    v_add_f32 v17, 1.0, v17
    v_add_f32 v18, 1.0, v18
    v_add_f32 v19, 1.0, v19
    v_add_f32 v20, 1.0, v20
    v_add_f32 v21, 1.0, v21
    v_add_f32 v22, 1.0, v22
    v_add_f32 v23, 1.0, v23
    v_add_f32 v24, 1.0, v24
    v_add_f32 v25, 1.0, v25
    v_add_f32 v26, 1.0, v26
    v_add_f32 v27, 1.0, v27
    s_add_u32 m0, m0, 4096
    s_cmp_eq_u32 s51, s52
    buffer_load_dwordx4 v162, s[28:31], s60 offen lds
    s_cselect_b32 s51, 0, s51
    v_rcp_f32 v8, v8
    v_rcp_f32 v9, v9
    v_rcp_f32 v10, v10
    v_rcp_f32 v11, v11
    v_rcp_f32 v12, v12
    v_rcp_f32 v13, v13
    v_rcp_f32 v14, v14
    v_rcp_f32 v15, v15
    v_rcp_f32 v16, v16
    v_rcp_f32 v17, v17
    v_rcp_f32 v18, v18
    v_rcp_f32 v19, v19
    v_rcp_f32 v20, v20
    v_rcp_f32 v21, v21
    v_rcp_f32 v22, v22
    s_cmp_lt_u32 s46, 2
    s_cselect_b32 s38, 92160, 0
    s_add_u32 s62, s62, s38
    s_mul_i32 s60, s51, 163840
    s_add_u32 s60, s60, s49
    s_add_u32 m0, s62, 56320
    s_add_u32 s51, s51, 1
    buffer_load_dwordx4 v158, s[28:31], s60 offen offset:0 lds
    buffer_load_dwordx4 v159, s[28:31], s60 offen offset:1024 lds
    v_rcp_f32 v23, v23
    v_rcp_f32 v24, v24
    v_rcp_f32 v25, v25
    v_rcp_f32 v26, v26
    v_rcp_f32 v27, v27
    v_mul_f32 v8, v28, v8
    v_mul_f32 v9, v29, v9
    v_mul_f32 v10, v30, v10
    v_mul_f32 v11, v31, v11
    v_mul_f32 v12, v32, v12
    v_mul_f32 v13, v33, v13
    v_mul_f32 v14, v34, v14
    v_mul_f32 v15, v35, v15
    v_mul_f32 v16, v36, v16
    v_mul_f32 v17, v37, v17
    buffer_load_dwordx4 v160, s[28:31], s60 offen offset:2048 lds
    buffer_load_dwordx4 v161, s[28:31], s60 offen offset:3072 lds
    v_mul_f32 v18, v38, v18
    v_mul_f32 v19, v39, v19
    v_mul_f32 v20, v40, v20
    v_mul_f32 v21, v41, v21
    v_mul_f32 v22, v42, v22
    v_mul_f32 v23, v43, v23
    v_mul_f32 v24, v44, v24
    v_mul_f32 v25, v45, v25
    v_mul_f32 v26, v46, v26
    v_mul_f32 v27, v47, v27
    v_mov_b32 v88, 0
    v_mov_b32 v89, 0
    v_mov_b32 v90, 0
    v_mov_b32 v91, 0
    v_mov_b32 v92, 0
    s_add_u32 m0, m0, 4096
    s_cmp_eq_u32 s51, s52
    buffer_load_dwordx4 v162, s[28:31], s60 offen lds
    s_cselect_b32 s51, 0, s51
    v_mov_b32 v93, 0
    v_mov_b32 v94, 0
    v_mov_b32 v95, 0
    v_mov_b32 v96, 0
    v_mov_b32 v97, 0
    v_mov_b32 v98, 0
    v_mov_b32 v99, 0
    v_mov_b32 v100, 0
    v_mov_b32 v101, 0
    v_mov_b32 v102, 0
    v_mov_b32 v103, 0
    v_mov_b32 v104, 0
    v_mov_b32 v105, 0
    v_mov_b32 v106, 0
    v_mov_b32 v107, 0
    s_branch L_g3_more
.p2align 6
L_g3:
    s_waitcnt lgkmcnt(10)
    v_mfma_f32_16x16x32_bf16 v[88:91], v[118:121], v[8:11], v[88:91]
    ds_read_b64_tr_b16 v[118:119], v3 offset:10240
    ds_read_b64_tr_b16 v[120:121], v3 offset:11520
    v_mfma_f32_16x16x32_bf16 v[92:95], v[122:125], v[8:11], v[92:95]
    ds_read_b64_tr_b16 v[122:123], v3 offset:10272
    ds_read_b64_tr_b16 v[124:125], v3 offset:11552
    v_mfma_f32_16x16x32_bf16 v[96:99], v[126:129], v[8:11], v[96:99]
    ds_read_b64_tr_b16 v[126:127], v3 offset:10304
    ds_read_b64_tr_b16 v[128:129], v3 offset:11584
    v_mfma_f32_16x16x32_bf16 v[100:103], v[130:133], v[8:11], v[100:103]
    ds_read_b64_tr_b16 v[130:131], v3 offset:10336
    ds_read_b64_tr_b16 v[132:133], v3 offset:11616
    v_mfma_f32_16x16x32_bf16 v[104:107], v[134:137], v[8:11], v[104:107]
    ds_read_b64_tr_b16 v[134:135], v3 offset:10368
    ds_read_b64_tr_b16 v[136:137], v3 offset:11648
    s_waitcnt lgkmcnt(10)
    v_mfma_f32_16x16x32_bf16 v[88:91], v[138:141], v[12:15], v[88:91]
    ds_read_b64_tr_b16 v[138:139], v3 offset:15360
    ds_read_b64_tr_b16 v[140:141], v3 offset:16640
    v_mfma_f32_16x16x32_bf16 v[92:95], v[142:145], v[12:15], v[92:95]
    ds_read_b64_tr_b16 v[142:143], v3 offset:15392
    ds_read_b64_tr_b16 v[144:145], v3 offset:16672
    v_mfma_f32_16x16x32_bf16 v[96:99], v[146:149], v[12:15], v[96:99]
    ds_read_b64_tr_b16 v[146:147], v3 offset:15424
    ds_read_b64_tr_b16 v[148:149], v3 offset:16704
    v_mfma_f32_16x16x32_bf16 v[100:103], v[150:153], v[12:15], v[100:103]
    ds_read_b64_tr_b16 v[150:151], v3 offset:15456
    ds_read_b64_tr_b16 v[152:153], v3 offset:16736
    v_mfma_f32_16x16x32_bf16 v[104:107], v[154:157], v[12:15], v[104:107]
    ds_read_b64_tr_b16 v[154:155], v3 offset:15488
    ds_read_b64_tr_b16 v[156:157], v3 offset:16768
L_o_w1:
    s_waitcnt vmcnt(12)
    v_max_u32 v7, v24, v26
    v_max3_u32 v7, v28, v30, v7
    v_max3_u32 v7, v32, v34, v7
    v_max3_u32 v7, v36, v38, v7
    v_cmp_eq_u32 s[58:59], -1, v7
    s_cmp_lg_u64 s[58:59], 0
    s_cbranch_scc1 L_o_r1
L_o_k1:
    s_waitcnt lgkmcnt(10)
    v_mfma_f32_16x16x32_bf16 v[88:91], v[118:121], v[16:19], v[88:91]
    ds_read_b64_tr_b16 v[118:119], v3 offset:20480
    ds_read_b64_tr_b16 v[120:121], v3 offset:21760
    v_mfma_f32_16x16x32_bf16 v[92:95], v[122:125], v[16:19], v[92:95]
    ds_read_b64_tr_b16 v[122:123], v3 offset:20512
    ds_read_b64_tr_b16 v[124:125], v3 offset:21792
    v_mfma_f32_16x16x32_bf16 v[96:99], v[126:129], v[16:19], v[96:99]
    ds_read_b64_tr_b16 v[126:127], v3 offset:20544
    ds_read_b64_tr_b16 v[128:129], v3 offset:21824
    v_mfma_f32_16x16x32_bf16 v[100:103], v[130:133], v[16:19], v[100:103]
    ds_read_b64_tr_b16 v[130:131], v3 offset:20576
    ds_read_b64_tr_b16 v[132:133], v3 offset:21856
    v_mfma_f32_16x16x32_bf16 v[104:107], v[134:137], v[16:19], v[104:107]
    ds_read_b64_tr_b16 v[134:135], v3 offset:20608
    ds_read_b64_tr_b16 v[136:137], v3 offset:21888
    s_waitcnt lgkmcnt(10)
    v_mfma_f32_16x16x32_bf16 v[88:91], v[138:141], v[20:23], v[88:91]
    ds_read_b64_tr_b16 v[138:139], v3 offset:25600
    ds_read_b64_tr_b16 v[140:141], v3 offset:26880
    v_mfma_f32_16x16x32_bf16 v[92:95], v[142:145], v[20:23], v[92:95]
    ds_read_b64_tr_b16 v[142:143], v3 offset:25632
    ds_read_b64_tr_b16 v[144:145], v3 offset:26912
    v_mfma_f32_16x16x32_bf16 v[96:99], v[146:149], v[20:23], v[96:99]
    ds_read_b64_tr_b16 v[146:147], v3 offset:25664
    ds_read_b64_tr_b16 v[148:149], v3 offset:26944
    v_mfma_f32_16x16x32_bf16 v[100:103], v[150:153], v[20:23], v[100:103]
    ds_read_b64_tr_b16 v[150:151], v3 offset:25696
    ds_read_b64_tr_b16 v[152:153], v3 offset:26976
    v_mfma_f32_16x16x32_bf16 v[104:107], v[154:157], v[20:23], v[104:107]
    ds_read_b64_tr_b16 v[154:155], v3 offset:25728
    ds_read_b64_tr_b16 v[156:157], v3 offset:27008
    s_waitcnt lgkmcnt(10)
    v_mfma_f32_16x16x32_bf16 v[88:91], v[118:121], v[24:27], v[88:91]
    ds_read_b64_tr_b16 v[118:119], v3 offset:30720
    ds_read_b64_tr_b16 v[120:121], v3 offset:32000
    v_mfma_f32_16x16x32_bf16 v[92:95], v[122:125], v[24:27], v[92:95]
    ds_read_b64_tr_b16 v[122:123], v3 offset:30752
    ds_read_b64_tr_b16 v[124:125], v3 offset:32032
    v_mfma_f32_16x16x32_bf16 v[96:99], v[126:129], v[24:27], v[96:99]
    ds_read_b64_tr_b16 v[126:127], v3 offset:30784
    ds_read_b64_tr_b16 v[128:129], v3 offset:32064
    v_mfma_f32_16x16x32_bf16 v[100:103], v[130:133], v[24:27], v[100:103]
    ds_read_b64_tr_b16 v[130:131], v3 offset:30816
    ds_read_b64_tr_b16 v[132:133], v3 offset:32096
    v_mfma_f32_16x16x32_bf16 v[104:107], v[134:137], v[24:27], v[104:107]
    ds_read_b64_tr_b16 v[134:135], v3 offset:30848
    ds_read_b64_tr_b16 v[136:137], v3 offset:32128
    s_waitcnt lgkmcnt(10)
    v_mfma_f32_16x16x32_bf16 v[88:91], v[138:141], v[28:31], v[88:91]
    ds_read_b64_tr_b16 v[138:139], v3 offset:35840
    ds_read_b64_tr_b16 v[140:141], v3 offset:37120
    v_mfma_f32_16x16x32_bf16 v[92:95], v[142:145], v[28:31], v[92:95]
    ds_read_b64_tr_b16 v[142:143], v3 offset:35872
    ds_read_b64_tr_b16 v[144:145], v3 offset:37152
    v_mfma_f32_16x16x32_bf16 v[96:99], v[146:149], v[28:31], v[96:99]
    ds_read_b64_tr_b16 v[146:147], v3 offset:35904
    ds_read_b64_tr_b16 v[148:149], v3 offset:37184
    v_mfma_f32_16x16x32_bf16 v[100:103], v[150:153], v[28:31], v[100:103]
    ds_read_b64_tr_b16 v[150:151], v3 offset:35936
    ds_read_b64_tr_b16 v[152:153], v3 offset:37216
    v_mfma_f32_16x16x32_bf16 v[104:107], v[154:157], v[28:31], v[104:107]
    ds_read_b64_tr_b16 v[154:155], v3 offset:35968
    ds_read_b64_tr_b16 v[156:157], v3 offset:37248
L_o_w2:
    s_waitcnt vmcnt(8)
    v_max_u32 v7, v40, v42
    v_max3_u32 v7, v44, v46, v7
    v_max3_u32 v7, v48, v50, v7
    v_max3_u32 v7, v52, v54, v7
    v_cmp_eq_u32 s[58:59], -1, v7
    s_cmp_lg_u64 s[58:59], 0
    s_cbranch_scc1 L_o_r2
L_o_k2:
    s_waitcnt lgkmcnt(10)
    v_mfma_f32_16x16x32_bf16 v[88:91], v[118:121], v[32:35], v[88:91]
    ds_read_b64_tr_b16 v[118:119], v4 offset:0
    ds_read_b64_tr_b16 v[120:121], v4 offset:1280
    v_mfma_f32_16x16x32_bf16 v[92:95], v[122:125], v[32:35], v[92:95]
    ds_read_b64_tr_b16 v[122:123], v4 offset:32
    ds_read_b64_tr_b16 v[124:125], v4 offset:1312
    v_mfma_f32_16x16x32_bf16 v[96:99], v[126:129], v[32:35], v[96:99]
    ds_read_b64_tr_b16 v[126:127], v4 offset:64
    ds_read_b64_tr_b16 v[128:129], v4 offset:1344
    v_mfma_f32_16x16x32_bf16 v[100:103], v[130:133], v[32:35], v[100:103]
    ds_read_b64_tr_b16 v[130:131], v4 offset:96
    ds_read_b64_tr_b16 v[132:133], v4 offset:1376
    v_mfma_f32_16x16x32_bf16 v[104:107], v[134:137], v[32:35], v[104:107]
    ds_read_b64_tr_b16 v[134:135], v4 offset:128
    ds_read_b64_tr_b16 v[136:137], v4 offset:1408
    s_waitcnt lgkmcnt(10)
    v_mfma_f32_16x16x32_bf16 v[88:91], v[138:141], v[36:39], v[88:91]
    ds_read_b64_tr_b16 v[138:139], v4 offset:5120
    ds_read_b64_tr_b16 v[140:141], v4 offset:6400
    v_mfma_f32_16x16x32_bf16 v[92:95], v[142:145], v[36:39], v[92:95]
    ds_read_b64_tr_b16 v[142:143], v4 offset:5152
    ds_read_b64_tr_b16 v[144:145], v4 offset:6432
    v_mfma_f32_16x16x32_bf16 v[96:99], v[146:149], v[36:39], v[96:99]
    ds_read_b64_tr_b16 v[146:147], v4 offset:5184
    ds_read_b64_tr_b16 v[148:149], v4 offset:6464
    v_mfma_f32_16x16x32_bf16 v[100:103], v[150:153], v[36:39], v[100:103]
    ds_read_b64_tr_b16 v[150:151], v4 offset:5216
    ds_read_b64_tr_b16 v[152:153], v4 offset:6496
    v_mfma_f32_16x16x32_bf16 v[104:107], v[154:157], v[36:39], v[104:107]
    ds_read_b64_tr_b16 v[154:155], v4 offset:5248
    ds_read_b64_tr_b16 v[156:157], v4 offset:6528
    s_waitcnt lgkmcnt(10)
    v_mfma_f32_16x16x32_bf16 v[88:91], v[118:121], v[40:43], v[88:91]
    ds_read_b64_tr_b16 v[118:119], v4 offset:10240
    ds_read_b64_tr_b16 v[120:121], v4 offset:11520
    v_mfma_f32_16x16x32_bf16 v[92:95], v[122:125], v[40:43], v[92:95]
    ds_read_b64_tr_b16 v[122:123], v4 offset:10272
    ds_read_b64_tr_b16 v[124:125], v4 offset:11552
    v_mfma_f32_16x16x32_bf16 v[96:99], v[126:129], v[40:43], v[96:99]
    ds_read_b64_tr_b16 v[126:127], v4 offset:10304
    ds_read_b64_tr_b16 v[128:129], v4 offset:11584
    v_mfma_f32_16x16x32_bf16 v[100:103], v[130:133], v[40:43], v[100:103]
    ds_read_b64_tr_b16 v[130:131], v4 offset:10336
    ds_read_b64_tr_b16 v[132:133], v4 offset:11616
    v_mfma_f32_16x16x32_bf16 v[104:107], v[134:137], v[40:43], v[104:107]
    ds_read_b64_tr_b16 v[134:135], v4 offset:10368
    ds_read_b64_tr_b16 v[136:137], v4 offset:11648
    s_waitcnt lgkmcnt(10)
    v_mfma_f32_16x16x32_bf16 v[88:91], v[138:141], v[44:47], v[88:91]
    ds_read_b64_tr_b16 v[138:139], v4 offset:15360
    ds_read_b64_tr_b16 v[140:141], v4 offset:16640
    v_mfma_f32_16x16x32_bf16 v[92:95], v[142:145], v[44:47], v[92:95]
    ds_read_b64_tr_b16 v[142:143], v4 offset:15392
    ds_read_b64_tr_b16 v[144:145], v4 offset:16672
    v_mfma_f32_16x16x32_bf16 v[96:99], v[146:149], v[44:47], v[96:99]
    ds_read_b64_tr_b16 v[146:147], v4 offset:15424
    ds_read_b64_tr_b16 v[148:149], v4 offset:16704
    v_mfma_f32_16x16x32_bf16 v[100:103], v[150:153], v[44:47], v[100:103]
    ds_read_b64_tr_b16 v[150:151], v4 offset:15456
    ds_read_b64_tr_b16 v[152:153], v4 offset:16736
    v_mfma_f32_16x16x32_bf16 v[104:107], v[154:157], v[44:47], v[104:107]
    ds_read_b64_tr_b16 v[154:155], v4 offset:15488
    ds_read_b64_tr_b16 v[156:157], v4 offset:16768
L_o_w3:
    s_waitcnt vmcnt(4)
    v_max_u32 v7, v56, v58
    v_max3_u32 v7, v60, v62, v7
    v_max3_u32 v7, v64, v66, v7
    v_max3_u32 v7, v68, v70, v7
    v_cmp_eq_u32 s[58:59], -1, v7
    s_cmp_lg_u64 s[58:59], 0
    s_cbranch_scc1 L_o_r3
L_o_k3:
    s_waitcnt lgkmcnt(10)
    v_mfma_f32_16x16x32_bf16 v[88:91], v[118:121], v[48:51], v[88:91]
    ds_read_b64_tr_b16 v[118:119], v4 offset:20480
    ds_read_b64_tr_b16 v[120:121], v4 offset:21760
    v_mfma_f32_16x16x32_bf16 v[92:95], v[122:125], v[48:51], v[92:95]
    ds_read_b64_tr_b16 v[122:123], v4 offset:20512
    ds_read_b64_tr_b16 v[124:125], v4 offset:21792
    v_mfma_f32_16x16x32_bf16 v[96:99], v[126:129], v[48:51], v[96:99]
    ds_read_b64_tr_b16 v[126:127], v4 offset:20544
    ds_read_b64_tr_b16 v[128:129], v4 offset:21824
    v_mfma_f32_16x16x32_bf16 v[100:103], v[130:133], v[48:51], v[100:103]
    ds_read_b64_tr_b16 v[130:131], v4 offset:20576
    ds_read_b64_tr_b16 v[132:133], v4 offset:21856
    v_mfma_f32_16x16x32_bf16 v[104:107], v[134:137], v[48:51], v[104:107]
    ds_read_b64_tr_b16 v[134:135], v4 offset:20608
    ds_read_b64_tr_b16 v[136:137], v4 offset:21888
    s_waitcnt lgkmcnt(10)
    v_mfma_f32_16x16x32_bf16 v[88:91], v[138:141], v[52:55], v[88:91]
    ds_read_b64_tr_b16 v[138:139], v4 offset:25600
    ds_read_b64_tr_b16 v[140:141], v4 offset:26880
    v_mfma_f32_16x16x32_bf16 v[92:95], v[142:145], v[52:55], v[92:95]
    ds_read_b64_tr_b16 v[142:143], v4 offset:25632
    ds_read_b64_tr_b16 v[144:145], v4 offset:26912
    v_mfma_f32_16x16x32_bf16 v[96:99], v[146:149], v[52:55], v[96:99]
    ds_read_b64_tr_b16 v[146:147], v4 offset:25664
    ds_read_b64_tr_b16 v[148:149], v4 offset:26944
    v_mfma_f32_16x16x32_bf16 v[100:103], v[150:153], v[52:55], v[100:103]
    ds_read_b64_tr_b16 v[150:151], v4 offset:25696
    ds_read_b64_tr_b16 v[152:153], v4 offset:26976
    v_mfma_f32_16x16x32_bf16 v[104:107], v[154:157], v[52:55], v[104:107]
    ds_read_b64_tr_b16 v[154:155], v4 offset:25728
    ds_read_b64_tr_b16 v[156:157], v4 offset:27008
    s_waitcnt lgkmcnt(10)
    v_mfma_f32_16x16x32_bf16 v[88:91], v[118:121], v[56:59], v[88:91]
    ds_read_b64_tr_b16 v[118:119], v4 offset:30720
    ds_read_b64_tr_b16 v[120:121], v4 offset:32000
    v_mfma_f32_16x16x32_bf16 v[92:95], v[122:125], v[56:59], v[92:95]
    ds_read_b64_tr_b16 v[122:123], v4 offset:30752
    ds_read_b64_tr_b16 v[124:125], v4 offset:32032
    v_mfma_f32_16x16x32_bf16 v[96:99], v[126:129], v[56:59], v[96:99]
    ds_read_b64_tr_b16 v[126:127], v4 offset:30784
    ds_read_b64_tr_b16 v[128:129], v4 offset:32064
    v_mfma_f32_16x16x32_bf16 v[100:103], v[130:133], v[56:59], v[100:103]
    ds_read_b64_tr_b16 v[130:131], v4 offset:30816
    ds_read_b64_tr_b16 v[132:133], v4 offset:32096
    v_mfma_f32_16x16x32_bf16 v[104:107], v[134:137], v[56:59], v[104:107]
    ds_read_b64_tr_b16 v[134:135], v4 offset:30848
    ds_read_b64_tr_b16 v[136:137], v4 offset:32128
    s_waitcnt lgkmcnt(10)
    v_mfma_f32_16x16x32_bf16 v[88:91], v[138:141], v[60:63], v[88:91]
    ds_read_b64_tr_b16 v[138:139], v4 offset:35840
    ds_read_b64_tr_b16 v[140:141], v4 offset:37120
    v_mfma_f32_16x16x32_bf16 v[92:95], v[142:145], v[60:63], v[92:95]
    ds_read_b64_tr_b16 v[142:143], v4 offset:35872
    ds_read_b64_tr_b16 v[144:145], v4 offset:37152
    v_mfma_f32_16x16x32_bf16 v[96:99], v[146:149], v[60:63], v[96:99]
    ds_read_b64_tr_b16 v[146:147], v4 offset:35904
    ds_read_b64_tr_b16 v[148:149], v4 offset:37184
    v_mfma_f32_16x16x32_bf16 v[100:103], v[150:153], v[60:63], v[100:103]
    ds_read_b64_tr_b16 v[150:151], v4 offset:35936
    ds_read_b64_tr_b16 v[152:153], v4 offset:37216
    v_mfma_f32_16x16x32_bf16 v[104:107], v[154:157], v[60:63], v[104:107]
    ds_read_b64_tr_b16 v[154:155], v4 offset:35968
    ds_read_b64_tr_b16 v[156:157], v4 offset:37248
L_o_w4:
    s_waitcnt vmcnt(0)
    v_max_u32 v7, v72, v74
    v_max3_u32 v7, v76, v78, v7
    v_max3_u32 v7, v80, v82, v7
    v_max3_u32 v7, v84, v86, v7
    v_cmp_eq_u32 s[58:59], -1, v7
    s_cmp_lg_u64 s[58:59], 0
    s_cbranch_scc1 L_o_r4
L_o_k4:
    s_waitcnt lgkmcnt(10)
    v_mfma_f32_16x16x32_bf16 v[88:91], v[118:121], v[64:67], v[88:91]
    ds_read_b64_tr_b16 v[118:119], v6 offset:0
    ds_read_b64_tr_b16 v[120:121], v6 offset:1280
    v_mfma_f32_16x16x32_bf16 v[92:95], v[122:125], v[64:67], v[92:95]
    ds_read_b64_tr_b16 v[122:123], v6 offset:32
    ds_read_b64_tr_b16 v[124:125], v6 offset:1312
    v_mfma_f32_16x16x32_bf16 v[96:99], v[126:129], v[64:67], v[96:99]
    ds_read_b64_tr_b16 v[126:127], v6 offset:64
    ds_read_b64_tr_b16 v[128:129], v6 offset:1344
    v_mfma_f32_16x16x32_bf16 v[100:103], v[130:133], v[64:67], v[100:103]
    ds_read_b64_tr_b16 v[130:131], v6 offset:96
    ds_read_b64_tr_b16 v[132:133], v6 offset:1376
    v_mfma_f32_16x16x32_bf16 v[104:107], v[134:137], v[64:67], v[104:107]
    ds_read_b64_tr_b16 v[134:135], v6 offset:128
    ds_read_b64_tr_b16 v[136:137], v6 offset:1408
    s_waitcnt lgkmcnt(10)
    v_mfma_f32_16x16x32_bf16 v[88:91], v[138:141], v[68:71], v[88:91]
    ds_read_b64_tr_b16 v[138:139], v6 offset:5120
    ds_read_b64_tr_b16 v[140:141], v6 offset:6400
    v_mfma_f32_16x16x32_bf16 v[92:95], v[142:145], v[68:71], v[92:95]
    ds_read_b64_tr_b16 v[142:143], v6 offset:5152
    ds_read_b64_tr_b16 v[144:145], v6 offset:6432
    v_mfma_f32_16x16x32_bf16 v[96:99], v[146:149], v[68:71], v[96:99]
    ds_read_b64_tr_b16 v[146:147], v6 offset:5184
    ds_read_b64_tr_b16 v[148:149], v6 offset:6464
    v_mfma_f32_16x16x32_bf16 v[100:103], v[150:153], v[68:71], v[100:103]
    ds_read_b64_tr_b16 v[150:151], v6 offset:5216
    ds_read_b64_tr_b16 v[152:153], v6 offset:6496
    v_mfma_f32_16x16x32_bf16 v[104:107], v[154:157], v[68:71], v[104:107]
    ds_read_b64_tr_b16 v[154:155], v6 offset:5248
    ds_read_b64_tr_b16 v[156:157], v6 offset:6528
    s_waitcnt lgkmcnt(10)
    v_mfma_f32_16x16x32_bf16 v[88:91], v[118:121], v[72:75], v[88:91]
    ds_read_b64_tr_b16 v[118:119], v3 offset:0
    ds_read_b64_tr_b16 v[120:121], v3 offset:1280
    v_mfma_f32_16x16x32_bf16 v[92:95], v[122:125], v[72:75], v[92:95]
    ds_read_b64_tr_b16 v[122:123], v3 offset:32
    ds_read_b64_tr_b16 v[124:125], v3 offset:1312
    v_mfma_f32_16x16x32_bf16 v[96:99], v[126:129], v[72:75], v[96:99]
    ds_read_b64_tr_b16 v[126:127], v3 offset:64
    ds_read_b64_tr_b16 v[128:129], v3 offset:1344
    v_mfma_f32_16x16x32_bf16 v[100:103], v[130:133], v[72:75], v[100:103]
    ds_read_b64_tr_b16 v[130:131], v3 offset:96
    ds_read_b64_tr_b16 v[132:133], v3 offset:1376
    v_mfma_f32_16x16x32_bf16 v[104:107], v[134:137], v[72:75], v[104:107]
    ds_read_b64_tr_b16 v[134:135], v3 offset:128
    ds_read_b64_tr_b16 v[136:137], v3 offset:1408
    s_waitcnt lgkmcnt(10)
    v_mfma_f32_16x16x32_bf16 v[88:91], v[138:141], v[76:79], v[88:91]
    ds_read_b64_tr_b16 v[138:139], v3 offset:5120
    ds_read_b64_tr_b16 v[140:141], v3 offset:6400
    v_mfma_f32_16x16x32_bf16 v[92:95], v[142:145], v[76:79], v[92:95]
    ds_read_b64_tr_b16 v[142:143], v3 offset:5152
    ds_read_b64_tr_b16 v[144:145], v3 offset:6432
    v_mfma_f32_16x16x32_bf16 v[96:99], v[146:149], v[76:79], v[96:99]
    ds_read_b64_tr_b16 v[146:147], v3 offset:5184
    ds_read_b64_tr_b16 v[148:149], v3 offset:6464
    v_mfma_f32_16x16x32_bf16 v[100:103], v[150:153], v[76:79], v[100:103]
    ds_read_b64_tr_b16 v[150:151], v3 offset:5216
    ds_read_b64_tr_b16 v[152:153], v3 offset:6496
    v_mfma_f32_16x16x32_bf16 v[104:107], v[154:157], v[76:79], v[104:107]
    ds_read_b64_tr_b16 v[154:155], v3 offset:5248
    ds_read_b64_tr_b16 v[156:157], v3 offset:6528
    s_waitcnt lgkmcnt(10)
    v_mfma_f32_16x16x32_bf16 v[88:91], v[118:121], v[80:83], v[88:91]
    v_lshlrev_b32 v8, 16, v108
    v_and_b32 v9, 0xffff0000, v108
    v_mfma_f32_16x16x32_bf16 v[92:95], v[122:125], v[80:83], v[92:95]
    v_lshlrev_b32 v28, 16, v158
    v_and_b32 v29, 0xffff0000, v158
    v_mfma_f32_16x16x32_bf16 v[96:99], v[126:129], v[80:83], v[96:99]
    v_lshlrev_b32 v10, 16, v109
    v_and_b32 v11, 0xffff0000, v109
    v_mfma_f32_16x16x32_bf16 v[100:103], v[130:133], v[80:83], v[100:103]
    v_lshlrev_b32 v30, 16, v159
    v_and_b32 v31, 0xffff0000, v159
    v_mfma_f32_16x16x32_bf16 v[104:107], v[134:137], v[80:83], v[104:107]
    s_waitcnt lgkmcnt(0)
    v_mfma_f32_16x16x32_bf16 v[88:91], v[138:141], v[84:87], v[88:91]
    v_lshlrev_b32 v12, 16, v110
    v_and_b32 v13, 0xffff0000, v110
    v_mfma_f32_16x16x32_bf16 v[92:95], v[142:145], v[84:87], v[92:95]
    v_lshlrev_b32 v32, 16, v160
    v_and_b32 v33, 0xffff0000, v160
    v_mfma_f32_16x16x32_bf16 v[96:99], v[146:149], v[84:87], v[96:99]
    v_lshlrev_b32 v14, 16, v111
    v_and_b32 v15, 0xffff0000, v111
    v_mfma_f32_16x16x32_bf16 v[100:103], v[150:153], v[84:87], v[100:103]
    v_lshlrev_b32 v34, 16, v161
    v_and_b32 v35, 0xffff0000, v161
    v_mfma_f32_16x16x32_bf16 v[104:107], v[154:157], v[84:87], v[104:107]
    v_lshlrev_b32 v16, 16, v112
    v_and_b32 v17, 0xffff0000, v112
    v_lshlrev_b32 v36, 16, v162
    v_and_b32 v37, 0xffff0000, v162
    v_lshlrev_b32 v18, 16, v113
    v_and_b32 v19, 0xffff0000, v113
    v_lshlrev_b32 v38, 16, v163
    v_and_b32 v39, 0xffff0000, v163
    v_lshlrev_b32 v20, 16, v114
    v_and_b32 v21, 0xffff0000, v114
    v_lshlrev_b32 v40, 16, v164
    v_and_b32 v41, 0xffff0000, v164
    v_lshlrev_b32 v22, 16, v115
    v_and_b32 v23, 0xffff0000, v115
    v_lshlrev_b32 v42, 16, v165
    v_and_b32 v43, 0xffff0000, v165
    v_lshlrev_b32 v24, 16, v116
    v_and_b32 v25, 0xffff0000, v116
    v_lshlrev_b32 v44, 16, v166
    v_and_b32 v45, 0xffff0000, v166
    v_lshlrev_b32 v26, 16, v117
    v_and_b32 v27, 0xffff0000, v117
    v_lshlrev_b32 v46, 16, v167
    v_and_b32 v47, 0xffff0000, v167
    v_fmac_f32 v8, v88, v28
    v_fmac_f32 v9, v89, v29
    v_fmac_f32 v10, v90, v30
    v_fmac_f32 v11, v91, v31
    v_fmac_f32 v12, v92, v32
    v_fmac_f32 v13, v93, v33
    v_fmac_f32 v14, v94, v34
    v_fmac_f32 v15, v95, v35
    v_fmac_f32 v16, v96, v36
    v_fmac_f32 v17, v97, v37
    v_fmac_f32 v18, v98, v38
    v_fmac_f32 v19, v99, v39
    v_fmac_f32 v20, v100, v40
    v_fmac_f32 v21, v101, v41
    v_fmac_f32 v22, v102, v42
    v_fmac_f32 v23, v103, v43
    v_fmac_f32 v24, v104, v44
    v_fmac_f32 v25, v105, v45
    v_fmac_f32 v26, v106, v46
    v_fmac_f32 v27, v107, v47
    v_cvt_pk_bf16_f32 v108, v8, v9
    v_cvt_pk_bf16_f32 v109, v10, v11
    v_cvt_pk_bf16_f32 v110, v12, v13
    v_cvt_pk_bf16_f32 v111, v14, v15
    v_cvt_pk_bf16_f32 v112, v16, v17
    v_cvt_pk_bf16_f32 v113, v18, v19
    v_cvt_pk_bf16_f32 v114, v20, v21
    v_cvt_pk_bf16_f32 v115, v22, v23
    v_cvt_pk_bf16_f32 v116, v24, v25
    v_cvt_pk_bf16_f32 v117, v26, v27
    buffer_store_dwordx2 v[116:117], v2, s[32:35], s48 offen offset:128
    v_permlane16_swap_b32 v108, v110
    v_permlane16_swap_b32 v109, v111
    buffer_store_dwordx4 v[108:111], v5, s[32:35], s48 offen offset:0
    v_permlane16_swap_b32 v112, v114
    v_permlane16_swap_b32 v113, v115
    buffer_store_dwordx4 v[112:115], v5, s[32:35], s48 offen offset:64
    s_endpgm
L_g3_more:
    s_mov_b32 s55, s47
    s_mov_b32 s54, s61
    s_waitcnt vmcnt(20)
    v_cmp_ne_u32 vcc, s37, v167
    s_cmp_eq_u64 vcc, 0
    s_waitcnt vmcnt(0)
    s_cbranch_scc1 L_g3_marked
    s_mov_b32 s43, 0
L_poll_35:
    buffer_load_dword v28, v7, s[24:27], s63 offen sc1
    s_add_u32 s43, s43, 1
    s_waitcnt vmcnt(0)
    v_xor_b32 v28, s37, v28
    v_cmp_ne_u32 vcc, 0, v28
    s_cmp_eq_u64 vcc, 0
    s_cbranch_scc1 L_polld_36
    s_sleep 1
    s_cmp_lt_u32 s43, 65536
    s_cbranch_scc1 L_poll_35
L_polld_36:
L_g3_marked:
    v_mov_b32 v164, s50
    ds_write_b32 v165, v164
    s_mov_b32 s43, 0
L_mt_37:
    ds_read_b32 v164, v163
    s_add_u32 s43, s43, 1
    s_waitcnt lgkmcnt(0)
    v_subrev_u32 v164, s50, v164
    v_cmp_lt_u32 s[58:59], 1, v164
    s_cmp_eq_u64 s[58:59], 0
    s_cbranch_scc1 L_mtd_38
    s_sleep 2
    s_cmp_lt_u32 s43, 1048576
    s_cbranch_scc1 L_mt_37
L_mtd_38:
    s_add_u32 s50, s50, 1
    v_cvt_pk_bf16_f32 v158, v8, v9
    v_cvt_pk_bf16_f32 v159, v10, v11
    v_cvt_pk_bf16_f32 v160, v12, v13
    v_cvt_pk_bf16_f32 v161, v14, v15
    v_cvt_pk_bf16_f32 v162, v16, v17
    v_cvt_pk_bf16_f32 v163, v18, v19
    v_cvt_pk_bf16_f32 v164, v20, v21
    v_cvt_pk_bf16_f32 v165, v22, v23
    v_cvt_pk_bf16_f32 v166, v24, v25
    v_cvt_pk_bf16_f32 v167, v26, v27
    v_add_u32 v6, 81920, v3
    v_and_b32 v8, 7, v0
    v_lshlrev_b32 v8, 2, v8
    v_add_u32 v8, 161968, v8
    s_mov_b32 s43, 0
L_og:
    ds_read_b32 v9, v8
    s_add_u32 s43, s43, 1
    s_waitcnt lgkmcnt(0)
    v_subrev_u32 v9, s37, v9
    v_cmp_lt_u32 vcc, 1, v9
    s_cmp_eq_u64 vcc, 0
    s_cbranch_scc1 L_ogd
    s_sleep 4
    s_cmp_lt_u32 s43, 1048576
    s_cbranch_scc1 L_og
L_ogd:
    s_mov_b64 vcc, 0
    s_mov_b32 s43, 0
    s_waitcnt vmcnt(0)
L_o_r0:
    s_add_u32 s54, s61, 0
    s_sub_u32 s38, s54, 5
    s_cselect_b32 s54, s54, s38
    s_lshl_b32 s40, s54, 13
    s_add_u32 s40, s40, s55
    s_add_u32 s39, s40, 4096
    buffer_load_dwordx4 v[8:11], v1, s[24:27], s40 offen offset:0 sc1
    buffer_load_dwordx4 v[12:15], v1, s[24:27], s40 offen offset:2048 sc1
    buffer_load_dwordx4 v[16:19], v1, s[24:27], s39 offen offset:0 sc1
    buffer_load_dwordx4 v[20:23], v1, s[24:27], s39 offen offset:2048 sc1
    s_add_u32 s54, s54, 1
    s_cmp_eq_u32 s54, 5
    s_cselect_b32 s54, 0, s54
    s_lshl_b32 s40, s54, 13
    s_add_u32 s40, s40, s55
    s_add_u32 s39, s40, 4096
    buffer_load_dwordx4 v[24:27], v1, s[24:27], s40 offen offset:0 sc1
    buffer_load_dwordx4 v[28:31], v1, s[24:27], s40 offen offset:2048 sc1
    buffer_load_dwordx4 v[32:35], v1, s[24:27], s39 offen offset:0 sc1
    buffer_load_dwordx4 v[36:39], v1, s[24:27], s39 offen offset:2048 sc1
    s_add_u32 s54, s54, 1
    s_cmp_eq_u32 s54, 5
    s_cselect_b32 s54, 0, s54
    s_mov_b32 s50, 0
    s_add_u32 s43, s43, 1
    s_cmp_ge_u32 s43, 65536
    s_waitcnt vmcnt(4)
    s_cbranch_scc1 L_o_l2
    v_max_u32 v7, v8, v10
    v_max3_u32 v7, v12, v14, v7
    v_max3_u32 v7, v16, v18, v7
    v_max3_u32 v7, v20, v22, v7
    v_cmp_eq_u32 s[58:59], -1, v7
    s_cmp_lg_u64 s[58:59], 0
    s_cbranch_scc1 L_o_r0
    s_branch L_o_l2
L_o_r1:
    s_add_u32 s54, s61, 1
    s_sub_u32 s38, s54, 5
    s_cselect_b32 s54, s54, s38
    s_lshl_b32 s40, s54, 13
    s_add_u32 s40, s40, s55
    s_add_u32 s39, s40, 4096
    buffer_load_dwordx4 v[24:27], v1, s[24:27], s40 offen offset:0 sc1
    buffer_load_dwordx4 v[28:31], v1, s[24:27], s40 offen offset:2048 sc1
    buffer_load_dwordx4 v[32:35], v1, s[24:27], s39 offen offset:0 sc1
    buffer_load_dwordx4 v[36:39], v1, s[24:27], s39 offen offset:2048 sc1
    s_add_u32 s54, s54, 1
    s_cmp_eq_u32 s54, 5
    s_cselect_b32 s54, 0, s54
    s_lshl_b32 s40, s54, 13
    s_add_u32 s40, s40, s55
    s_add_u32 s39, s40, 4096
    buffer_load_dwordx4 v[40:43], v1, s[24:27], s40 offen offset:0 sc1
    buffer_load_dwordx4 v[44:47], v1, s[24:27], s40 offen offset:2048 sc1
    buffer_load_dwordx4 v[48:51], v1, s[24:27], s39 offen offset:0 sc1
    buffer_load_dwordx4 v[52:55], v1, s[24:27], s39 offen offset:2048 sc1
    s_add_u32 s54, s54, 1
    s_cmp_eq_u32 s54, 5
    s_cselect_b32 s54, 0, s54
    s_mov_b32 s50, 1
    s_add_u32 s43, s43, 1
    s_cmp_ge_u32 s43, 65536
    s_waitcnt vmcnt(4)
    s_cbranch_scc1 L_o_l3
    v_max_u32 v7, v24, v26
    v_max3_u32 v7, v28, v30, v7
    v_max3_u32 v7, v32, v34, v7
    v_max3_u32 v7, v36, v38, v7
    v_cmp_eq_u32 s[58:59], -1, v7
    s_cmp_lg_u64 s[58:59], 0
    s_cbranch_scc1 L_o_r1
    s_branch L_o_l3
L_o_r2:
    s_add_u32 s54, s61, 2
    s_sub_u32 s38, s54, 5
    s_cselect_b32 s54, s54, s38
    s_lshl_b32 s40, s54, 13
    s_add_u32 s40, s40, s55
    s_add_u32 s39, s40, 4096
    buffer_load_dwordx4 v[40:43], v1, s[24:27], s40 offen offset:0 sc1
    buffer_load_dwordx4 v[44:47], v1, s[24:27], s40 offen offset:2048 sc1
    buffer_load_dwordx4 v[48:51], v1, s[24:27], s39 offen offset:0 sc1
    buffer_load_dwordx4 v[52:55], v1, s[24:27], s39 offen offset:2048 sc1
    s_add_u32 s54, s54, 1
    s_cmp_eq_u32 s54, 5
    s_cselect_b32 s54, 0, s54
    s_lshl_b32 s40, s54, 13
    s_add_u32 s40, s40, s55
    s_add_u32 s39, s40, 4096
    buffer_load_dwordx4 v[56:59], v1, s[24:27], s40 offen offset:0 sc1
    buffer_load_dwordx4 v[60:63], v1, s[24:27], s40 offen offset:2048 sc1
    buffer_load_dwordx4 v[64:67], v1, s[24:27], s39 offen offset:0 sc1
    buffer_load_dwordx4 v[68:71], v1, s[24:27], s39 offen offset:2048 sc1
    s_add_u32 s54, s54, 1
    s_cmp_eq_u32 s54, 5
    s_cselect_b32 s54, 0, s54
    s_mov_b32 s50, 2
    s_add_u32 s43, s43, 1
    s_cmp_ge_u32 s43, 65536
    s_waitcnt vmcnt(4)
    s_cbranch_scc1 L_o_l4
    v_max_u32 v7, v40, v42
    v_max3_u32 v7, v44, v46, v7
    v_max3_u32 v7, v48, v50, v7
    v_max3_u32 v7, v52, v54, v7
    v_cmp_eq_u32 s[58:59], -1, v7
    s_cmp_lg_u64 s[58:59], 0
    s_cbranch_scc1 L_o_r2
    s_branch L_o_l4
L_o_r3:
    s_add_u32 s54, s61, 3
    s_sub_u32 s38, s54, 5
    s_cselect_b32 s54, s54, s38
    s_lshl_b32 s40, s54, 13
    s_add_u32 s40, s40, s55
    s_add_u32 s39, s40, 4096
    buffer_load_dwordx4 v[56:59], v1, s[24:27], s40 offen offset:0 sc1
    buffer_load_dwordx4 v[60:63], v1, s[24:27], s40 offen offset:2048 sc1
    buffer_load_dwordx4 v[64:67], v1, s[24:27], s39 offen offset:0 sc1
    buffer_load_dwordx4 v[68:71], v1, s[24:27], s39 offen offset:2048 sc1
    s_add_u32 s54, s54, 1
    s_cmp_eq_u32 s54, 5
    s_cselect_b32 s54, 0, s54
    s_lshl_b32 s40, s54, 13
    s_add_u32 s40, s40, s55
    s_add_u32 s39, s40, 4096
    buffer_load_dwordx4 v[72:75], v1, s[24:27], s40 offen offset:0 sc1
    buffer_load_dwordx4 v[76:79], v1, s[24:27], s40 offen offset:2048 sc1
    buffer_load_dwordx4 v[80:83], v1, s[24:27], s39 offen offset:0 sc1
    buffer_load_dwordx4 v[84:87], v1, s[24:27], s39 offen offset:2048 sc1
    s_add_u32 s54, s54, 1
    s_cmp_eq_u32 s54, 5
    s_cselect_b32 s54, 0, s54
    s_mov_b32 s50, 3
    s_add_u32 s43, s43, 1
    s_cmp_ge_u32 s43, 65536
    s_waitcnt vmcnt(4)
    s_cbranch_scc1 L_o_l5
    v_max_u32 v7, v56, v58
    v_max3_u32 v7, v60, v62, v7
    v_max3_u32 v7, v64, v66, v7
    v_max3_u32 v7, v68, v70, v7
    v_cmp_eq_u32 s[58:59], -1, v7
    s_cmp_lg_u64 s[58:59], 0
    s_cbranch_scc1 L_o_r3
    s_branch L_o_l5
L_o_r4:
    s_add_u32 s54, s61, 4
    s_sub_u32 s38, s54, 5
    s_cselect_b32 s54, s54, s38
    s_lshl_b32 s40, s54, 13
    s_add_u32 s40, s40, s55
    s_add_u32 s39, s40, 4096
    buffer_load_dwordx4 v[72:75], v1, s[24:27], s40 offen offset:0 sc1
    buffer_load_dwordx4 v[76:79], v1, s[24:27], s40 offen offset:2048 sc1
    buffer_load_dwordx4 v[80:83], v1, s[24:27], s39 offen offset:0 sc1
    buffer_load_dwordx4 v[84:87], v1, s[24:27], s39 offen offset:2048 sc1
    s_add_u32 s54, s54, 1
    s_cmp_eq_u32 s54, 5
    s_cselect_b32 s54, 0, s54
    s_mov_b32 s50, 4
    s_add_u32 s43, s43, 1
    s_cmp_ge_u32 s43, 65536
    s_waitcnt vmcnt(0)
    s_cbranch_scc1 L_o_l5
    v_max_u32 v7, v72, v74
    v_max3_u32 v7, v76, v78, v7
    v_max3_u32 v7, v80, v82, v7
    v_max3_u32 v7, v84, v86, v7
    v_cmp_eq_u32 s[58:59], -1, v7
    s_cmp_lg_u64 s[58:59], 0
    s_cbranch_scc1 L_o_r4
    s_branch L_o_l5
L_o_l1:
    s_lshl_b32 s40, s54, 13
    s_add_u32 s40, s40, s55
    s_add_u32 s39, s40, 4096
    buffer_load_dwordx4 v[24:27], v1, s[24:27], s40 offen offset:0 sc1
    buffer_load_dwordx4 v[28:31], v1, s[24:27], s40 offen offset:2048 sc1
    buffer_load_dwordx4 v[32:35], v1, s[24:27], s39 offen offset:0 sc1
    buffer_load_dwordx4 v[36:39], v1, s[24:27], s39 offen offset:2048 sc1
    s_add_u32 s54, s54, 1
    s_cmp_eq_u32 s54, 5
    s_cselect_b32 s54, 0, s54
L_o_l2:
    s_lshl_b32 s40, s54, 13
    s_add_u32 s40, s40, s55
    s_add_u32 s39, s40, 4096
    buffer_load_dwordx4 v[40:43], v1, s[24:27], s40 offen offset:0 sc1
    buffer_load_dwordx4 v[44:47], v1, s[24:27], s40 offen offset:2048 sc1
    buffer_load_dwordx4 v[48:51], v1, s[24:27], s39 offen offset:0 sc1
    buffer_load_dwordx4 v[52:55], v1, s[24:27], s39 offen offset:2048 sc1
    s_add_u32 s54, s54, 1
    s_cmp_eq_u32 s54, 5
    s_cselect_b32 s54, 0, s54
L_o_l3:
    s_lshl_b32 s40, s54, 13
    s_add_u32 s40, s40, s55
    s_add_u32 s39, s40, 4096
    buffer_load_dwordx4 v[56:59], v1, s[24:27], s40 offen offset:0 sc1
    buffer_load_dwordx4 v[60:63], v1, s[24:27], s40 offen offset:2048 sc1
    buffer_load_dwordx4 v[64:67], v1, s[24:27], s39 offen offset:0 sc1
    buffer_load_dwordx4 v[68:71], v1, s[24:27], s39 offen offset:2048 sc1
    s_add_u32 s54, s54, 1
    s_cmp_eq_u32 s54, 5
    s_cselect_b32 s54, 0, s54
L_o_l4:
    s_lshl_b32 s40, s54, 13
    s_add_u32 s40, s40, s55
    s_add_u32 s39, s40, 4096
    buffer_load_dwordx4 v[72:75], v1, s[24:27], s40 offen offset:0 sc1
    buffer_load_dwordx4 v[76:79], v1, s[24:27], s40 offen offset:2048 sc1
    buffer_load_dwordx4 v[80:83], v1, s[24:27], s39 offen offset:0 sc1
    buffer_load_dwordx4 v[84:87], v1, s[24:27], s39 offen offset:2048 sc1
    s_add_u32 s54, s54, 1
    s_cmp_eq_u32 s54, 5
    s_cselect_b32 s54, 0, s54
L_o_l5:
    s_cmp_eq_u32 s50, 4
    s_cbranch_scc1 L_o_k4
    s_cmp_eq_u32 s50, 3
    s_cbranch_scc1 L_o_k3
    s_cmp_eq_u32 s50, 2
    s_cbranch_scc1 L_o_k2
    s_cmp_eq_u32 s50, 1
    s_cbranch_scc1 L_o_k1
    s_branch L_g3
L_end:
    s_endpgm
.section .rodata,"a"
.p2align 6
.amdhsa_kernel recurrent_scan__mha_block__dense_activation_relu__prompt_kernel
  .amdhsa_next_free_vgpr 168
  .amdhsa_next_free_sgpr 68
  .amdhsa_accum_offset 168
  .amdhsa_group_segment_fixed_size 0
  .amdhsa_kernarg_size 72
  .amdhsa_user_sgpr_count 2
  .amdhsa_user_sgpr_kernarg_segment_ptr 1
  .amdhsa_system_sgpr_workgroup_id_x 1
  .amdhsa_float_denorm_mode_32 3
.end_amdhsa_kernel
```
